```python
import torch

def _softmax(x, axis=-1):
    return torch.softmax(x, dim=axis)
def _gelu(x):
    return torch.nn.functional.gelu(x, approximate="tanh")
def _silu(x):
    return torch.nn.functional.silu(x)
def _sigmoid(x):
    return torch.sigmoid(x)
def _layernorm(x, axis=-1, eps=1e-5):
    m = x.mean(dim=axis, keepdim=True)
    v = x.var(dim=axis, keepdim=True, unbiased=False)
    return (x - m) / torch.sqrt(v + eps)
def _scatter_add(tgt, idx, src, axis=0):
    return tgt.clone().index_add_(axis, idx, src)
def _segment_sum(src, seg, n):
    out = torch.zeros((n,) + src.shape[1:], dtype=src.dtype)
    return out.index_add_(0, seg, src)
def _pad(x, pw):
    flat = tuple(v for pair in reversed(pw) for v in pair)
    return torch.nn.functional.pad(x, flat)

kernel_name = 'interleave_layers__ssm_conv_h3__glu_gated_swiglu__prompt'

def setup_inputs():

    _w = (lambda a: (lambda t: t.to(torch.bfloat16) if t.is_floating_point() else t)(torch.as_tensor(a)))
    def _A_setup():
        B, S, D = 1, 2048, 576
        ks = 4
        return {
            "q": _w((lambda *s: torch.randn(*s, dtype=torch.bfloat16) * 0.05)(B, S, D)),
            "k": _w((lambda *s: torch.randn(*s, dtype=torch.bfloat16) * 0.2)(B, S, D)),
            "v": _w((lambda *s: torch.randn(*s, dtype=torch.bfloat16) * 0.2)(B, S, D)),
            "shift_k": _w((lambda *s: torch.randn(*s, dtype=torch.bfloat16) * 0.2)(D, ks) * 0.5),
            "ssm_k": _w((lambda *s: torch.randn(*s, dtype=torch.bfloat16) * 0.4)(D, S) * (1.0 / S ** 0.5)),
            "ssm_D": _w((lambda *s: torch.randn(*s, dtype=torch.bfloat16) * 0.2)(D)),
        }
    _A_in = _A_setup()

    def _B_setup():
        B, S, D, F = 1, 2048, 576, 4608
        return {
            "x": _w((lambda *s: torch.randn(*s, dtype=torch.bfloat16) * 0.05)(B, S, D)),
            "w1": _w((lambda *s: torch.randn(*s, dtype=torch.bfloat16) * 0.2)(D, F) * (2.0 / D) ** 0.5),
            "w3": _w((lambda *s: torch.randn(*s, dtype=torch.bfloat16) * 0.2)(D, F) * (2.0 / D) ** 0.5),
            "w2": _w((lambda *s: torch.randn(*s, dtype=torch.bfloat16) * 0.2)(F, D) * (2.0 / F) ** 0.5),
        }
    _B_in = _B_setup()

    return {
        "A_q": _A_in["q"],
        "A_k": _A_in["k"],
        "A_v": _A_in["v"],
        "A_shift_k": _A_in["shift_k"],
        "A_ssm_k": _A_in["ssm_k"],
        "A_ssm_D": _A_in["ssm_D"],
        "B_x": _B_in["x"],
        "B_w1": _B_in["w1"],
        "B_w3": _B_in["w3"],
        "B_w2": _B_in["w2"],
    }

def reference(A_q, A_k, A_v, A_shift_k, A_ssm_k, A_ssm_D, B_x, B_w1, B_w3, B_w2):
    def _A_ref(q, k, v, shift_k, ssm_k, ssm_D):
        B, S, D = q.shape
        ks = shift_k.shape[-1]
        k_pad = _pad(k, ((0, 0), (ks - 1, 0), (0, 0)))
        k_shift = torch.zeros_like(k)
        for t in range(ks):
            k_shift = k_shift + k_pad[:, t:t + S, :] * shift_k[:, ks - 1 - t][None, None, :]
        kv = k_shift * v
        L = 2 * S
        kv_pad = _pad(kv, ((0, 0), (0, S), (0, 0)))
        kf_pad = _pad(ssm_k, ((0, 0), (0, S)))
        kv_f = (lambda x, axes=(-2,-1): torch.fft.rfft2(x.float(), dim=axes))(kv_pad[:, None, :, :], axes=(1, 2))
        kf_f = (lambda x, axes=(-2,-1): torch.fft.rfft2(x.float(), dim=axes))(kf_pad[:, None, :], axes=(1, 2))
        kf_f = (lambda x, *d: x.permute(*d))(kf_f, 1, 2, 0)
        y_f = kv_f * kf_f[None, :, :, :]
        y = (lambda x, s, axes=(-2,-1): torch.fft.irfft2(x, s=s, dim=axes).to(torch.bfloat16))(y_f, (1, L), axes=(1, 2))[:, 0, :S, :]
        y = y + kv * ssm_D[None, None, :]
        return q * y

    def _B_ref(x, w1, w3, w2):
        gate = torch.einsum("bsd,df->bsf", x, w1)
        up = torch.einsum("bsd,df->bsf", x, w3)
        h = _silu(gate) * up
        out = torch.einsum("bsf,fd->bsd", h, w2)
        return out

    x = A_q
    x = x + _A_ref(_layernorm(x, axis=-1), A_k, A_v, A_shift_k, A_ssm_k, A_ssm_D)
    x = x + _B_ref(_layernorm(x, axis=-1), B_w1, B_w3, B_w2)
    x = x + _A_ref(_layernorm(x, axis=-1), A_k, A_v, A_shift_k, A_ssm_k, A_ssm_D)
    x = x + _B_ref(_layernorm(x, axis=-1), B_w1, B_w3, B_w2)
    return x
```

```asm
; @launch kernel=pre_kernel grid=(288,1,1) block=(512,1,1) lds=9216
; @launch kernel=conv_kernel grid=(576,1,1) block=(256,1,1) lds=55040
; @launch kernel=row0_kernel grid=(256,1,1) block=(512,1,1) lds=9344
; @launch kernel=gemm1_kernel grid=(256,1,1) block=(768,1,1) lds=139264
; @launch kernel=gemm2_kernel grid=(256,1,1) block=(768,1,1) lds=139264
; @launch kernel=row1_kernel grid=(256,1,1) block=(512,1,1) lds=9344
; @launch kernel=gemm1_kernel grid=(256,1,1) block=(768,1,1) lds=139264
; @launch kernel=gemm2_kernel grid=(256,1,1) block=(768,1,1) lds=139264
; @launch kernel=row2_kernel grid=(256,1,1) block=(512,1,1) lds=0
.amdgcn_target "amdgcn-amd-amdhsa--gfx950"
.text
.globl pre_kernel
.p2align 8
.type pre_kernel,@function
pre_kernel:
    s_cmp_ge_u32 s2, 288
    s_cbranch_scc1 pre_done
    s_load_dwordx4 s[4:7], s[0:1], 8
    s_load_dwordx2 s[8:9], s[0:1], 24
    s_load_dwordx2 s[14:15], s[0:1], 96
    s_mul_hi_u32 s20, s2, 477218589
    s_mul_i32 s3, s20, 9
    s_sub_u32 s21, s2, s3
    s_mov_b32 s23, 0xffff0000
    v_lshrrev_b32 v1, 3, v0
    v_and_b32 v2, 7, v0
    s_lshl_b32 s3, s20, 6
    v_add_u32 v3, s3, v1
    v_mul_u32_u24 v3, 1152, v3
    s_lshl_b32 s3, s21, 7
    v_lshl_add_u32 v4, v2, 4, s3
    v_add_u32 v3, v3, v4
    v_lshlrev_b32 v4, 2, v4
    s_waitcnt lgkmcnt(0)

    s_mov_b32 s24, s4
    s_mov_b32 s25, s5
    s_mov_b32 s26, 2359296
    s_mov_b32 s27, 0x00020000
    s_mov_b32 s28, s6
    s_mov_b32 s29, s7
    s_mov_b32 s30, 2359296
    s_mov_b32 s31, 0x00020000
    s_mov_b32 s32, s8
    s_mov_b32 s33, s9
    s_mov_b32 s34, 4608
    s_mov_b32 s35, 0x00020000
    s_add_u32 s36, s14, 83886080
    s_addc_u32 s37, s15, 0
    s_mov_b32 s38, 2359296
    s_mov_b32 s39, 0x00020000
    v_subrev_u32 v5, 1152, v3
    v_subrev_u32 v6, 2304, v3
    v_subrev_u32 v7, 3456, v3
    buffer_load_dwordx4 v[8:11], v7, s[24:27], 0 offen
    buffer_load_dwordx4 v[12:15], v6, s[24:27], 0 offen
    buffer_load_dwordx4 v[16:19], v5, s[24:27], 0 offen
    buffer_load_dwordx4 v[20:23], v3, s[24:27], 0 offen
    buffer_load_dwordx4 v[24:27], v3, s[28:31], 0 offen
    buffer_load_dwordx4 v[40:43], v4, s[32:35], 0 offen
    buffer_load_dwordx4 v[44:47], v4, s[32:35], 0 offen offset:16
    buffer_load_dwordx4 v[48:51], v4, s[32:35], 0 offen offset:32
    buffer_load_dwordx4 v[52:55], v4, s[32:35], 0 offen offset:48
    v_mul_u32_u24 v56, 1152, v2
    v_lshl_add_u32 v56, v1, 1, v56
    s_waitcnt vmcnt(0)

    v_and_b32 v34, s23, v41
    v_and_b32 v35, s23, v43
    v_lshlrev_b32 v28, 16, v8
    v_and_b32 v29, s23, v8
    v_mul_f32 v28, v34, v28
    v_mul_f32 v29, v35, v29

    v_cvt_pk_bf16_f32 v30, v28, v29
    v_lshlrev_b32 v34, 16, v41
    v_lshlrev_b32 v35, 16, v43
    v_lshlrev_b32 v28, 16, v12
    v_and_b32 v29, s23, v12
    v_mul_f32 v28, v34, v28
    v_mul_f32 v29, v35, v29

    v_cvt_pk_bf16_f32 v31, v28, v29
    v_lshlrev_b32 v28, 16, v30
    v_and_b32 v29, s23, v30
    v_lshlrev_b32 v32, 16, v31
    v_and_b32 v33, s23, v31
    v_add_f32 v28, v28, v32
    v_add_f32 v29, v29, v33
    v_cvt_pk_bf16_f32 v30, v28, v29

    v_and_b32 v34, s23, v40
    v_and_b32 v35, s23, v42
    v_lshlrev_b32 v28, 16, v16
    v_and_b32 v29, s23, v16
    v_mul_f32 v28, v34, v28
    v_mul_f32 v29, v35, v29

    v_cvt_pk_bf16_f32 v31, v28, v29
    v_lshlrev_b32 v28, 16, v30
    v_and_b32 v29, s23, v30
    v_lshlrev_b32 v32, 16, v31
    v_and_b32 v33, s23, v31
    v_add_f32 v28, v28, v32
    v_add_f32 v29, v29, v33
    v_cvt_pk_bf16_f32 v30, v28, v29

    v_lshlrev_b32 v34, 16, v40
    v_lshlrev_b32 v35, 16, v42
    v_lshlrev_b32 v28, 16, v20
    v_and_b32 v29, s23, v20
    v_mul_f32 v28, v34, v28
    v_mul_f32 v29, v35, v29

    v_cvt_pk_bf16_f32 v31, v28, v29
    v_lshlrev_b32 v28, 16, v30
    v_and_b32 v29, s23, v30
    v_lshlrev_b32 v32, 16, v31
    v_and_b32 v33, s23, v31
    v_add_f32 v28, v28, v32
    v_add_f32 v29, v29, v33
    v_cvt_pk_bf16_f32 v30, v28, v29

    v_lshlrev_b32 v28, 16, v30
    v_and_b32 v29, s23, v30
    v_lshlrev_b32 v32, 16, v24
    v_and_b32 v33, s23, v24
    v_mul_f32 v28, v28, v32
    v_mul_f32 v29, v29, v33
    v_cvt_pk_bf16_f32 v36, v28, v29
    ds_write_b16 v56, v36 offset:0
    ds_write_b16_d16_hi v56, v36 offset:144

    v_and_b32 v34, s23, v45
    v_and_b32 v35, s23, v47
    v_lshlrev_b32 v28, 16, v9
    v_and_b32 v29, s23, v9
    v_mul_f32 v28, v34, v28
    v_mul_f32 v29, v35, v29

    v_cvt_pk_bf16_f32 v30, v28, v29
    v_lshlrev_b32 v34, 16, v45
    v_lshlrev_b32 v35, 16, v47
    v_lshlrev_b32 v28, 16, v13
    v_and_b32 v29, s23, v13
    v_mul_f32 v28, v34, v28
    v_mul_f32 v29, v35, v29

    v_cvt_pk_bf16_f32 v31, v28, v29
    v_lshlrev_b32 v28, 16, v30
    v_and_b32 v29, s23, v30
    v_lshlrev_b32 v32, 16, v31
    v_and_b32 v33, s23, v31
    v_add_f32 v28, v28, v32
    v_add_f32 v29, v29, v33
    v_cvt_pk_bf16_f32 v30, v28, v29

    v_and_b32 v34, s23, v44
    v_and_b32 v35, s23, v46
    v_lshlrev_b32 v28, 16, v17
    v_and_b32 v29, s23, v17
    v_mul_f32 v28, v34, v28
    v_mul_f32 v29, v35, v29

    v_cvt_pk_bf16_f32 v31, v28, v29
    v_lshlrev_b32 v28, 16, v30
    v_and_b32 v29, s23, v30
    v_lshlrev_b32 v32, 16, v31
    v_and_b32 v33, s23, v31
    v_add_f32 v28, v28, v32
    v_add_f32 v29, v29, v33
    v_cvt_pk_bf16_f32 v30, v28, v29

    v_lshlrev_b32 v34, 16, v44
    v_lshlrev_b32 v35, 16, v46
    v_lshlrev_b32 v28, 16, v21
    v_and_b32 v29, s23, v21
    v_mul_f32 v28, v34, v28
    v_mul_f32 v29, v35, v29

    v_cvt_pk_bf16_f32 v31, v28, v29
    v_lshlrev_b32 v28, 16, v30
    v_and_b32 v29, s23, v30
    v_lshlrev_b32 v32, 16, v31
    v_and_b32 v33, s23, v31
    v_add_f32 v28, v28, v32
    v_add_f32 v29, v29, v33
    v_cvt_pk_bf16_f32 v30, v28, v29

    v_lshlrev_b32 v28, 16, v30
    v_and_b32 v29, s23, v30
    v_lshlrev_b32 v32, 16, v25
    v_and_b32 v33, s23, v25
    v_mul_f32 v28, v28, v32
    v_mul_f32 v29, v29, v33
    v_cvt_pk_bf16_f32 v37, v28, v29
    ds_write_b16 v56, v37 offset:288
    ds_write_b16_d16_hi v56, v37 offset:432

    v_and_b32 v34, s23, v49
    v_and_b32 v35, s23, v51
    v_lshlrev_b32 v28, 16, v10
    v_and_b32 v29, s23, v10
    v_mul_f32 v28, v34, v28
    v_mul_f32 v29, v35, v29

    v_cvt_pk_bf16_f32 v30, v28, v29
    v_lshlrev_b32 v34, 16, v49
    v_lshlrev_b32 v35, 16, v51
    v_lshlrev_b32 v28, 16, v14
    v_and_b32 v29, s23, v14
    v_mul_f32 v28, v34, v28
    v_mul_f32 v29, v35, v29

    v_cvt_pk_bf16_f32 v31, v28, v29
    v_lshlrev_b32 v28, 16, v30
    v_and_b32 v29, s23, v30
    v_lshlrev_b32 v32, 16, v31
    v_and_b32 v33, s23, v31
    v_add_f32 v28, v28, v32
    v_add_f32 v29, v29, v33
    v_cvt_pk_bf16_f32 v30, v28, v29

    v_and_b32 v34, s23, v48
    v_and_b32 v35, s23, v50
    v_lshlrev_b32 v28, 16, v18
    v_and_b32 v29, s23, v18
    v_mul_f32 v28, v34, v28
    v_mul_f32 v29, v35, v29

    v_cvt_pk_bf16_f32 v31, v28, v29
    v_lshlrev_b32 v28, 16, v30
    v_and_b32 v29, s23, v30
    v_lshlrev_b32 v32, 16, v31
    v_and_b32 v33, s23, v31
    v_add_f32 v28, v28, v32
    v_add_f32 v29, v29, v33
    v_cvt_pk_bf16_f32 v30, v28, v29

    v_lshlrev_b32 v34, 16, v48
    v_lshlrev_b32 v35, 16, v50
    v_lshlrev_b32 v28, 16, v22
    v_and_b32 v29, s23, v22
    v_mul_f32 v28, v34, v28
    v_mul_f32 v29, v35, v29

    v_cvt_pk_bf16_f32 v31, v28, v29
    v_lshlrev_b32 v28, 16, v30
    v_and_b32 v29, s23, v30
    v_lshlrev_b32 v32, 16, v31
    v_and_b32 v33, s23, v31
    v_add_f32 v28, v28, v32
    v_add_f32 v29, v29, v33
    v_cvt_pk_bf16_f32 v30, v28, v29

    v_lshlrev_b32 v28, 16, v30
    v_and_b32 v29, s23, v30
    v_lshlrev_b32 v32, 16, v26
    v_and_b32 v33, s23, v26
    v_mul_f32 v28, v28, v32
    v_mul_f32 v29, v29, v33
    v_cvt_pk_bf16_f32 v38, v28, v29
    ds_write_b16 v56, v38 offset:576
    ds_write_b16_d16_hi v56, v38 offset:720

    v_and_b32 v34, s23, v53
    v_and_b32 v35, s23, v55
    v_lshlrev_b32 v28, 16, v11
    v_and_b32 v29, s23, v11
    v_mul_f32 v28, v34, v28
    v_mul_f32 v29, v35, v29

    v_cvt_pk_bf16_f32 v30, v28, v29
    v_lshlrev_b32 v34, 16, v53
    v_lshlrev_b32 v35, 16, v55
    v_lshlrev_b32 v28, 16, v15
    v_and_b32 v29, s23, v15
    v_mul_f32 v28, v34, v28
    v_mul_f32 v29, v35, v29

    v_cvt_pk_bf16_f32 v31, v28, v29
    v_lshlrev_b32 v28, 16, v30
    v_and_b32 v29, s23, v30
    v_lshlrev_b32 v32, 16, v31
    v_and_b32 v33, s23, v31
    v_add_f32 v28, v28, v32
    v_add_f32 v29, v29, v33
    v_cvt_pk_bf16_f32 v30, v28, v29

    v_and_b32 v34, s23, v52
    v_and_b32 v35, s23, v54
    v_lshlrev_b32 v28, 16, v19
    v_and_b32 v29, s23, v19
    v_mul_f32 v28, v34, v28
    v_mul_f32 v29, v35, v29

    v_cvt_pk_bf16_f32 v31, v28, v29
    v_lshlrev_b32 v28, 16, v30
    v_and_b32 v29, s23, v30
    v_lshlrev_b32 v32, 16, v31
    v_and_b32 v33, s23, v31
    v_add_f32 v28, v28, v32
    v_add_f32 v29, v29, v33
    v_cvt_pk_bf16_f32 v30, v28, v29

    v_lshlrev_b32 v34, 16, v52
    v_lshlrev_b32 v35, 16, v54
    v_lshlrev_b32 v28, 16, v23
    v_and_b32 v29, s23, v23
    v_mul_f32 v28, v34, v28
    v_mul_f32 v29, v35, v29

    v_cvt_pk_bf16_f32 v31, v28, v29
    v_lshlrev_b32 v28, 16, v30
    v_and_b32 v29, s23, v30
    v_lshlrev_b32 v32, 16, v31
    v_and_b32 v33, s23, v31
    v_add_f32 v28, v28, v32
    v_add_f32 v29, v29, v33
    v_cvt_pk_bf16_f32 v30, v28, v29

    v_lshlrev_b32 v28, 16, v30
    v_and_b32 v29, s23, v30
    v_lshlrev_b32 v32, 16, v27
    v_and_b32 v33, s23, v27
    v_mul_f32 v28, v28, v32
    v_mul_f32 v29, v29, v33
    v_cvt_pk_bf16_f32 v39, v28, v29
    ds_write_b16 v56, v39 offset:864
    ds_write_b16_d16_hi v56, v39 offset:1008

    s_waitcnt lgkmcnt(0)
    s_barrier
    v_mul_u32_u24 v4, 144, v1
    v_lshl_add_u32 v4, v2, 4, v4
    ds_read_b128 v[8:11], v4
    s_lshl_b32 s3, s21, 6
    v_add_u32 v5, s3, v1
    v_lshlrev_b32 v5, 12, v5
    v_lshl_add_u32 v5, v2, 4, v5
    s_lshl_b32 s3, s20, 7
    v_add_u32 v5, s3, v5
    s_waitcnt lgkmcnt(0)
    buffer_store_dwordx4 v[8:11], v5, s[36:39], 0 offen

pre_done:
    s_endpgm
.globl conv_kernel
.p2align 8
.type conv_kernel,@function
conv_kernel:
    s_cmp_ge_u32 s2, 576
    s_cbranch_scc1 conv_done
    s_load_dwordx4 s[8:11], s[0:1], 32
    s_load_dwordx2 s[14:15], s[0:1], 96
    s_mov_b32 s23, 0xffff0000
    s_and_b32 s3, s2, 0xfffe
    s_lshl_b32 s3, s3, 1
    s_waitcnt lgkmcnt(0)
    s_add_u32 s10, s10, s3
    s_addc_u32 s11, s11, 0
    s_load_dword s49, s[10:11], 0

    s_add_u32 s24, s14, 83886080
    s_addc_u32 s25, s15, 0
    s_mov_b32 s26, 2359296
    s_mov_b32 s27, 0x00020000
    s_mov_b32 s28, s8
    s_mov_b32 s29, s9
    s_mov_b32 s30, 2359296
    s_mov_b32 s31, 0x00020000
    s_mov_b32 s32, s14
    s_mov_b32 s33, s15
    s_mov_b32 s34, 2359296
    s_mov_b32 s35, 0x00020000
    s_lshl_b32 s47, s2, 12
    v_lshlrev_b32 v1, 4, v0
    v_add_u32 v2, s47, v1
    v_subrev_u32 v3, 8, v2
    buffer_load_dwordx4 v[4:7], v2, s[24:27], 0 offen
    buffer_load_dwordx2 v[16:17], v3, s[28:31], 0 offen
    buffer_load_dwordx4 v[18:21], v2, s[28:31], 0 offen
    v_mov_b32 v8, 0
    v_mov_b32 v9, 0
    v_mov_b32 v10, 0
    v_mov_b32 v11, 0
    v_cmp_eq_u32 s[50:51], 0, v0
    v_cmp_gt_u32 vcc, 64, v0
    s_and_saveexec_b64 s[52:53], vcc
    ds_write_b128 v1, v[8:11]
    v_and_b32 v12, 15, v0
    v_lshrrev_b32 v13, 2, v12
    v_mul_u32_u24 v13, 4288, v13
    v_and_b32 v12, 3, v12
    v_lshl_add_u32 v13, v12, 4, v13
    ds_write_b128 v13, v[8:11] offset:5120
    s_mov_b64 exec, s[52:53]
    s_waitcnt vmcnt(0)
    ds_write_b128 v1, v[4:7] offset:1024
    v_cndmask_b32 v16, v16, 0, s[50:51]
    v_cndmask_b32 v17, v17, 0, s[50:51]
    v_alignbit_b32 v22, v17, v16, 16
    v_alignbit_b32 v23, v18, v17, 16
    v_alignbit_b32 v24, v19, v18, 16
    v_alignbit_b32 v25, v20, v19, 16
    v_alignbit_b32 v26, v21, v20, 16
    v_mov_b32 v28, v17
    v_mov_b32 v29, v18
    v_mov_b32 v30, v19
    v_mov_b32 v31, v20
    v_mov_b32 v32, v23
    v_mov_b32 v33, v24
    v_mov_b32 v34, v25
    v_mov_b32 v35, v26
    ds_write_b128 v1, v[18:21] offset:5184
    ds_write_b128 v1, v[32:35] offset:9472
    ds_write_b128 v1, v[28:31] offset:13760
    ds_write_b128 v1, v[22:25] offset:18048
    v_lshrrev_b32 v1, 6, v0
    v_and_b32 v2, 63, v0
    s_nop 0
    v_readfirstlane_b32 s22, v1
    s_nop 3
    v_lshrrev_b32 v4, 4, v2
    v_and_b32 v5, 3, v2
    v_bfe_u32 v6, v2, 2, 2
    v_mul_u32_u24 v6, 4288, v6
    v_lshlrev_b32 v7, 4, v4
    v_sub_u32 v6, v6, v7
    v_lshlrev_b32 v7, 3, v5
    v_add_u32 v6, v6, v7
    s_lshl_b32 s3, s22, 6
    s_add_u32 s3, s3, 5176
    v_add_u32 v12, s3, v6
    v_and_b32 v7, 15, v2
    v_lshlrev_b32 v8, 6, v7
    v_lshl_add_u32 v8, v4, 4, v8
    s_lshl_b32 s3, s22, 6
    s_sub_u32 s3, 64, s3
    v_add_u32 v13, s3, v8
    v_lshlrev_b32 v9, 6, v7
    v_lshl_add_u32 v9, v4, 3, v9
    s_lshl_b32 s3, s22, 10
    s_add_u32 s3, s3, 1024
    v_add_u32 v9, s3, v9
    s_lshl_b32 s3, s22, 4
    v_add_u32 v10, s3, v7
    v_mul_u32_u24 v10, 36864, v10
    v_lshl_add_u32 v10, v4, 3, v10
    s_lshl_b32 s3, s2, 6
    v_add_u32 v10, s3, v10
    v_lshlrev_b32 v11, 4, v2
    s_lshl_b32 s3, s22, 13
    s_add_u32 s3, s3, 22272
    v_add_u32 v14, s3, v11
    s_lshl_b32 s3, s22, 11
    s_add_u32 s3, s3, 22272
    v_add_u32 v15, s3, v11

    v_mov_b32 v16, 0
    v_mov_b32 v17, 0
    v_mov_b32 v18, 0
    v_mov_b32 v19, 0
    v_mov_b32 v20, 0
    v_mov_b32 v21, 0
    v_mov_b32 v22, 0
    v_mov_b32 v23, 0
    v_mov_b32 v24, 0
    v_mov_b32 v25, 0
    v_mov_b32 v26, 0
    v_mov_b32 v27, 0
    v_mov_b32 v28, 0
    v_mov_b32 v29, 0
    v_mov_b32 v30, 0
    v_mov_b32 v31, 0
    v_mov_b32 v32, 0
    v_mov_b32 v33, 0
    v_mov_b32 v34, 0
    v_mov_b32 v35, 0
    v_mov_b32 v36, 0
    v_mov_b32 v37, 0
    v_mov_b32 v38, 0
    v_mov_b32 v39, 0
    v_mov_b32 v40, 0
    v_mov_b32 v41, 0
    v_mov_b32 v42, 0
    v_mov_b32 v43, 0
    v_mov_b32 v44, 0
    v_mov_b32 v45, 0
    v_mov_b32 v46, 0
    v_mov_b32 v47, 0
    s_waitcnt lgkmcnt(0)
    s_barrier
    ds_read_b64_tr_b16 v[48:49], v12 offset:8
    ds_read_b64_tr_b16 v[50:51], v12 offset:0
    ds_read_b64_tr_b16 v[52:53], v12 offset:40
    ds_read_b64_tr_b16 v[54:55], v12 offset:32

    ds_read_b128 v[56:59], v13 offset:960
    ds_read_b128 v[60:63], v13 offset:1984
    ds_read_b128 v[64:67], v13 offset:3008
    ds_read_b128 v[68:71], v13 offset:4032
    ds_read_b64_tr_b16 v[72:73], v12 offset:264
    ds_read_b64_tr_b16 v[74:75], v12 offset:256
    ds_read_b64_tr_b16 v[76:77], v12 offset:296
    ds_read_b64_tr_b16 v[78:79], v12 offset:288

    ds_read_b128 v[80:83], v13 offset:704
    ds_read_b128 v[84:87], v13 offset:1728
    ds_read_b128 v[88:91], v13 offset:2752
    ds_read_b128 v[92:95], v13 offset:3776
    ds_read_b64_tr_b16 v[96:97], v12 offset:520
    ds_read_b64_tr_b16 v[98:99], v12 offset:512
    ds_read_b64_tr_b16 v[100:101], v12 offset:552
    ds_read_b64_tr_b16 v[102:103], v12 offset:544

    ds_read_b128 v[104:107], v13 offset:448
    ds_read_b128 v[108:111], v13 offset:1472
    ds_read_b128 v[112:115], v13 offset:2496
    ds_read_b128 v[116:119], v13 offset:3520
    ds_read_b64_tr_b16 v[120:121], v12 offset:776
    ds_read_b64_tr_b16 v[122:123], v12 offset:768
    ds_read_b64_tr_b16 v[124:125], v12 offset:808
    ds_read_b64_tr_b16 v[126:127], v12 offset:800

    ds_read_b128 v[128:131], v13 offset:192
    ds_read_b128 v[132:135], v13 offset:1216
    ds_read_b128 v[136:139], v13 offset:2240
    ds_read_b128 v[140:143], v13 offset:3264
    s_waitcnt lgkmcnt(15)
    v_mfma_f32_16x16x32_bf16 v[16:19], v[48:51], v[56:59], v[16:19]
    v_mfma_f32_16x16x32_bf16 v[20:23], v[52:55], v[56:59], v[20:23]

    v_mfma_f32_16x16x32_bf16 v[24:27], v[48:51], v[60:63], v[24:27]
    v_mfma_f32_16x16x32_bf16 v[28:31], v[52:55], v[60:63], v[28:31]

    v_mfma_f32_16x16x32_bf16 v[32:35], v[48:51], v[64:67], v[32:35]
    v_mfma_f32_16x16x32_bf16 v[36:39], v[52:55], v[64:67], v[36:39]

    v_mfma_f32_16x16x32_bf16 v[40:43], v[48:51], v[68:71], v[40:43]
    v_mfma_f32_16x16x32_bf16 v[44:47], v[52:55], v[68:71], v[44:47]

    s_waitcnt lgkmcnt(15)
    v_mfma_f32_16x16x32_bf16 v[16:19], v[72:75], v[80:83], v[16:19]
    v_mfma_f32_16x16x32_bf16 v[20:23], v[76:79], v[80:83], v[20:23]

    v_mfma_f32_16x16x32_bf16 v[24:27], v[72:75], v[84:87], v[24:27]
    v_mfma_f32_16x16x32_bf16 v[28:31], v[76:79], v[84:87], v[28:31]

    v_mfma_f32_16x16x32_bf16 v[32:35], v[72:75], v[88:91], v[32:35]
    v_mfma_f32_16x16x32_bf16 v[36:39], v[76:79], v[88:91], v[36:39]

    v_mfma_f32_16x16x32_bf16 v[40:43], v[72:75], v[92:95], v[40:43]
    v_mfma_f32_16x16x32_bf16 v[44:47], v[76:79], v[92:95], v[44:47]

    s_waitcnt lgkmcnt(8)
    v_mfma_f32_16x16x32_bf16 v[16:19], v[96:99], v[104:107], v[16:19]
    v_mfma_f32_16x16x32_bf16 v[20:23], v[100:103], v[104:107], v[20:23]

    v_mfma_f32_16x16x32_bf16 v[24:27], v[96:99], v[108:111], v[24:27]
    v_mfma_f32_16x16x32_bf16 v[28:31], v[100:103], v[108:111], v[28:31]

    v_mfma_f32_16x16x32_bf16 v[32:35], v[96:99], v[112:115], v[32:35]
    v_mfma_f32_16x16x32_bf16 v[36:39], v[100:103], v[112:115], v[36:39]

    v_mfma_f32_16x16x32_bf16 v[40:43], v[96:99], v[116:119], v[40:43]
    v_mfma_f32_16x16x32_bf16 v[44:47], v[100:103], v[116:119], v[44:47]

    s_waitcnt lgkmcnt(0)
    v_mfma_f32_16x16x32_bf16 v[16:19], v[120:123], v[128:131], v[16:19]
    v_mfma_f32_16x16x32_bf16 v[20:23], v[124:127], v[128:131], v[20:23]

    v_mfma_f32_16x16x32_bf16 v[24:27], v[120:123], v[132:135], v[24:27]
    v_mfma_f32_16x16x32_bf16 v[28:31], v[124:127], v[132:135], v[28:31]

    v_mfma_f32_16x16x32_bf16 v[32:35], v[120:123], v[136:139], v[32:35]
    v_mfma_f32_16x16x32_bf16 v[36:39], v[124:127], v[136:139], v[36:39]

    v_mfma_f32_16x16x32_bf16 v[40:43], v[120:123], v[140:143], v[40:43]
    v_mfma_f32_16x16x32_bf16 v[44:47], v[124:127], v[140:143], v[44:47]

    ds_read_b64_tr_b16 v[48:49], v12 offset:1032
    ds_read_b64_tr_b16 v[50:51], v12 offset:1024
    ds_read_b64_tr_b16 v[52:53], v12 offset:1064
    ds_read_b64_tr_b16 v[54:55], v12 offset:1056

    ds_read_b128 v[56:59], v13 offset:960
    ds_read_b128 v[60:63], v13 offset:1984
    ds_read_b128 v[64:67], v13 offset:3008
    ds_read_b64_tr_b16 v[72:73], v12 offset:1288
    ds_read_b64_tr_b16 v[74:75], v12 offset:1280
    ds_read_b64_tr_b16 v[76:77], v12 offset:1320
    ds_read_b64_tr_b16 v[78:79], v12 offset:1312

    ds_read_b128 v[80:83], v13 offset:704
    ds_read_b128 v[84:87], v13 offset:1728
    ds_read_b128 v[88:91], v13 offset:2752
    ds_read_b64_tr_b16 v[96:97], v12 offset:1544
    ds_read_b64_tr_b16 v[98:99], v12 offset:1536
    ds_read_b64_tr_b16 v[100:101], v12 offset:1576
    ds_read_b64_tr_b16 v[102:103], v12 offset:1568

    ds_read_b128 v[104:107], v13 offset:448
    ds_read_b128 v[108:111], v13 offset:1472
    ds_read_b128 v[112:115], v13 offset:2496
    ds_read_b64_tr_b16 v[120:121], v12 offset:1800
    ds_read_b64_tr_b16 v[122:123], v12 offset:1792
    ds_read_b64_tr_b16 v[124:125], v12 offset:1832
    ds_read_b64_tr_b16 v[126:127], v12 offset:1824

    ds_read_b128 v[128:131], v13 offset:192
    ds_read_b128 v[132:135], v13 offset:1216
    ds_read_b128 v[136:139], v13 offset:2240
    s_waitcnt lgkmcnt(15)
    v_mfma_f32_16x16x32_bf16 v[24:27], v[48:51], v[56:59], v[24:27]
    v_mfma_f32_16x16x32_bf16 v[28:31], v[52:55], v[56:59], v[28:31]

    v_mfma_f32_16x16x32_bf16 v[32:35], v[48:51], v[60:63], v[32:35]
    v_mfma_f32_16x16x32_bf16 v[36:39], v[52:55], v[60:63], v[36:39]

    v_mfma_f32_16x16x32_bf16 v[40:43], v[48:51], v[64:67], v[40:43]
    v_mfma_f32_16x16x32_bf16 v[44:47], v[52:55], v[64:67], v[44:47]

    s_waitcnt lgkmcnt(14)
    v_mfma_f32_16x16x32_bf16 v[24:27], v[72:75], v[80:83], v[24:27]
    v_mfma_f32_16x16x32_bf16 v[28:31], v[76:79], v[80:83], v[28:31]

    v_mfma_f32_16x16x32_bf16 v[32:35], v[72:75], v[84:87], v[32:35]
    v_mfma_f32_16x16x32_bf16 v[36:39], v[76:79], v[84:87], v[36:39]

    v_mfma_f32_16x16x32_bf16 v[40:43], v[72:75], v[88:91], v[40:43]
    v_mfma_f32_16x16x32_bf16 v[44:47], v[76:79], v[88:91], v[44:47]

    s_waitcnt lgkmcnt(7)
    v_mfma_f32_16x16x32_bf16 v[24:27], v[96:99], v[104:107], v[24:27]
    v_mfma_f32_16x16x32_bf16 v[28:31], v[100:103], v[104:107], v[28:31]

    v_mfma_f32_16x16x32_bf16 v[32:35], v[96:99], v[108:111], v[32:35]
    v_mfma_f32_16x16x32_bf16 v[36:39], v[100:103], v[108:111], v[36:39]

    v_mfma_f32_16x16x32_bf16 v[40:43], v[96:99], v[112:115], v[40:43]
    v_mfma_f32_16x16x32_bf16 v[44:47], v[100:103], v[112:115], v[44:47]

    s_waitcnt lgkmcnt(0)
    v_mfma_f32_16x16x32_bf16 v[24:27], v[120:123], v[128:131], v[24:27]
    v_mfma_f32_16x16x32_bf16 v[28:31], v[124:127], v[128:131], v[28:31]

    v_mfma_f32_16x16x32_bf16 v[32:35], v[120:123], v[132:135], v[32:35]
    v_mfma_f32_16x16x32_bf16 v[36:39], v[124:127], v[132:135], v[36:39]

    v_mfma_f32_16x16x32_bf16 v[40:43], v[120:123], v[136:139], v[40:43]
    v_mfma_f32_16x16x32_bf16 v[44:47], v[124:127], v[136:139], v[44:47]

    ds_read_b64_tr_b16 v[48:49], v12 offset:2056
    ds_read_b64_tr_b16 v[50:51], v12 offset:2048
    ds_read_b64_tr_b16 v[52:53], v12 offset:2088
    ds_read_b64_tr_b16 v[54:55], v12 offset:2080

    ds_read_b128 v[56:59], v13 offset:960
    ds_read_b128 v[60:63], v13 offset:1984
    ds_read_b64_tr_b16 v[72:73], v12 offset:2312
    ds_read_b64_tr_b16 v[74:75], v12 offset:2304
    ds_read_b64_tr_b16 v[76:77], v12 offset:2344
    ds_read_b64_tr_b16 v[78:79], v12 offset:2336

    ds_read_b128 v[80:83], v13 offset:704
    ds_read_b128 v[84:87], v13 offset:1728
    ds_read_b64_tr_b16 v[96:97], v12 offset:2568
    ds_read_b64_tr_b16 v[98:99], v12 offset:2560
    ds_read_b64_tr_b16 v[100:101], v12 offset:2600
    ds_read_b64_tr_b16 v[102:103], v12 offset:2592

    ds_read_b128 v[104:107], v13 offset:448
    ds_read_b128 v[108:111], v13 offset:1472
    ds_read_b64_tr_b16 v[120:121], v12 offset:2824
    ds_read_b64_tr_b16 v[122:123], v12 offset:2816
    ds_read_b64_tr_b16 v[124:125], v12 offset:2856
    ds_read_b64_tr_b16 v[126:127], v12 offset:2848

    ds_read_b128 v[128:131], v13 offset:192
    ds_read_b128 v[132:135], v13 offset:1216
    s_waitcnt lgkmcnt(15)
    v_mfma_f32_16x16x32_bf16 v[32:35], v[48:51], v[56:59], v[32:35]
    v_mfma_f32_16x16x32_bf16 v[36:39], v[52:55], v[56:59], v[36:39]

    v_mfma_f32_16x16x32_bf16 v[40:43], v[48:51], v[60:63], v[40:43]
    v_mfma_f32_16x16x32_bf16 v[44:47], v[52:55], v[60:63], v[44:47]

    s_waitcnt lgkmcnt(12)
    v_mfma_f32_16x16x32_bf16 v[32:35], v[72:75], v[80:83], v[32:35]
    v_mfma_f32_16x16x32_bf16 v[36:39], v[76:79], v[80:83], v[36:39]

    v_mfma_f32_16x16x32_bf16 v[40:43], v[72:75], v[84:87], v[40:43]
    v_mfma_f32_16x16x32_bf16 v[44:47], v[76:79], v[84:87], v[44:47]

    s_waitcnt lgkmcnt(6)
    v_mfma_f32_16x16x32_bf16 v[32:35], v[96:99], v[104:107], v[32:35]
    v_mfma_f32_16x16x32_bf16 v[36:39], v[100:103], v[104:107], v[36:39]

    v_mfma_f32_16x16x32_bf16 v[40:43], v[96:99], v[108:111], v[40:43]
    v_mfma_f32_16x16x32_bf16 v[44:47], v[100:103], v[108:111], v[44:47]

    s_waitcnt lgkmcnt(0)
    v_mfma_f32_16x16x32_bf16 v[32:35], v[120:123], v[128:131], v[32:35]
    v_mfma_f32_16x16x32_bf16 v[36:39], v[124:127], v[128:131], v[36:39]

    v_mfma_f32_16x16x32_bf16 v[40:43], v[120:123], v[132:135], v[40:43]
    v_mfma_f32_16x16x32_bf16 v[44:47], v[124:127], v[132:135], v[44:47]

    ds_read_b64_tr_b16 v[48:49], v12 offset:3080
    ds_read_b64_tr_b16 v[50:51], v12 offset:3072
    ds_read_b64_tr_b16 v[52:53], v12 offset:3112
    ds_read_b64_tr_b16 v[54:55], v12 offset:3104

    ds_read_b128 v[56:59], v13 offset:960
    ds_read_b64_tr_b16 v[72:73], v12 offset:3336
    ds_read_b64_tr_b16 v[74:75], v12 offset:3328
    ds_read_b64_tr_b16 v[76:77], v12 offset:3368
    ds_read_b64_tr_b16 v[78:79], v12 offset:3360

    ds_read_b128 v[80:83], v13 offset:704
    ds_read_b64_tr_b16 v[96:97], v12 offset:3592
    ds_read_b64_tr_b16 v[98:99], v12 offset:3584
    ds_read_b64_tr_b16 v[100:101], v12 offset:3624
    ds_read_b64_tr_b16 v[102:103], v12 offset:3616

    ds_read_b128 v[104:107], v13 offset:448
    ds_read_b64_tr_b16 v[120:121], v12 offset:3848
    ds_read_b64_tr_b16 v[122:123], v12 offset:3840
    ds_read_b64_tr_b16 v[124:125], v12 offset:3880
    ds_read_b64_tr_b16 v[126:127], v12 offset:3872

    ds_read_b128 v[128:131], v13 offset:192
    s_waitcnt lgkmcnt(15)
    v_mfma_f32_16x16x32_bf16 v[40:43], v[48:51], v[56:59], v[40:43]
    v_mfma_f32_16x16x32_bf16 v[44:47], v[52:55], v[56:59], v[44:47]

    s_waitcnt lgkmcnt(10)
    v_mfma_f32_16x16x32_bf16 v[40:43], v[72:75], v[80:83], v[40:43]
    v_mfma_f32_16x16x32_bf16 v[44:47], v[76:79], v[80:83], v[44:47]

    s_waitcnt lgkmcnt(5)
    v_mfma_f32_16x16x32_bf16 v[40:43], v[96:99], v[104:107], v[40:43]
    v_mfma_f32_16x16x32_bf16 v[44:47], v[100:103], v[104:107], v[44:47]

    s_waitcnt lgkmcnt(0)
    v_mfma_f32_16x16x32_bf16 v[40:43], v[120:123], v[128:131], v[40:43]
    v_mfma_f32_16x16x32_bf16 v[44:47], v[124:127], v[128:131], v[44:47]

    s_nop 7
    s_nop 7
    ds_write_b128 v14, v[16:19] offset:0
    ds_write_b128 v14, v[20:23] offset:1024
    ds_write_b128 v14, v[24:27] offset:2048
    ds_write_b128 v14, v[28:31] offset:3072
    ds_write_b128 v14, v[32:35] offset:4096
    ds_write_b128 v14, v[36:39] offset:5120
    ds_write_b128 v14, v[40:43] offset:6144
    ds_write_b128 v14, v[44:47] offset:7168
    ds_read_b64 v[88:89], v9
    ds_read_b64 v[90:91], v9 offset:32
    s_and_b32 s3, s2, 1
    s_lshl_b32 s46, s49, 16
    s_and_b32 s49, s49, 0xffff0000
    s_cmp_eq_u32 s3, 0
    s_cselect_b32 s49, s46, s49
    s_waitcnt lgkmcnt(0)
    s_barrier

    ds_read_b128 v[48:51], v15 offset:0
    ds_read_b128 v[52:55], v15 offset:1024
    ds_read_b128 v[56:59], v15 offset:8192
    ds_read_b128 v[60:63], v15 offset:9216
    ds_read_b128 v[64:67], v15 offset:16384
    ds_read_b128 v[68:71], v15 offset:17408
    ds_read_b128 v[72:75], v15 offset:24576
    ds_read_b128 v[76:79], v15 offset:25600
    s_waitcnt lgkmcnt(0)
    v_add_f32 v48, v48, v56
    v_add_f32 v64, v64, v72
    v_add_f32 v40, v48, v64

    v_add_f32 v49, v49, v57
    v_add_f32 v65, v65, v73
    v_add_f32 v41, v49, v65

    v_add_f32 v50, v50, v58
    v_add_f32 v66, v66, v74
    v_add_f32 v42, v50, v66

    v_add_f32 v51, v51, v59
    v_add_f32 v67, v67, v75
    v_add_f32 v43, v51, v67

    v_add_f32 v52, v52, v60
    v_add_f32 v68, v68, v76
    v_add_f32 v44, v52, v68

    v_add_f32 v53, v53, v61
    v_add_f32 v69, v69, v77
    v_add_f32 v45, v53, v69

    v_add_f32 v54, v54, v62
    v_add_f32 v70, v70, v78
    v_add_f32 v46, v54, v70

    v_add_f32 v55, v55, v63
    v_add_f32 v71, v71, v79
    v_add_f32 v47, v55, v71

    v_cvt_pk_bf16_f32 v52, v40, v41
    v_lshlrev_b32 v53, 16, v88
    v_and_b32 v54, s23, v88
    v_mul_f32 v53, s49, v53
    v_mul_f32 v54, s49, v54
    v_cvt_pk_bf16_f32 v55, v53, v54
    v_lshlrev_b32 v53, 16, v52
    v_and_b32 v54, s23, v52
    v_lshlrev_b32 v56, 16, v55
    v_and_b32 v57, s23, v55
    v_add_f32 v53, v53, v56
    v_add_f32 v54, v54, v57
    v_cvt_pk_bf16_f32 v58, v53, v54

    v_cvt_pk_bf16_f32 v52, v42, v43
    v_lshlrev_b32 v53, 16, v89
    v_and_b32 v54, s23, v89
    v_mul_f32 v53, s49, v53
    v_mul_f32 v54, s49, v54
    v_cvt_pk_bf16_f32 v55, v53, v54
    v_lshlrev_b32 v53, 16, v52
    v_and_b32 v54, s23, v52
    v_lshlrev_b32 v56, 16, v55
    v_and_b32 v57, s23, v55
    v_add_f32 v53, v53, v56
    v_add_f32 v54, v54, v57
    v_cvt_pk_bf16_f32 v59, v53, v54

    buffer_store_dwordx2 v[58:59], v10, s[32:35], 0 offen offset:0
    v_cvt_pk_bf16_f32 v52, v44, v45
    v_lshlrev_b32 v53, 16, v90
    v_and_b32 v54, s23, v90
    v_mul_f32 v53, s49, v53
    v_mul_f32 v54, s49, v54
    v_cvt_pk_bf16_f32 v55, v53, v54
    v_lshlrev_b32 v53, 16, v52
    v_and_b32 v54, s23, v52
    v_lshlrev_b32 v56, 16, v55
    v_and_b32 v57, s23, v55
    v_add_f32 v53, v53, v56
    v_add_f32 v54, v54, v57
    v_cvt_pk_bf16_f32 v60, v53, v54

    v_cvt_pk_bf16_f32 v52, v46, v47
    v_lshlrev_b32 v53, 16, v91
    v_and_b32 v54, s23, v91
    v_mul_f32 v53, s49, v53
    v_mul_f32 v54, s49, v54
    v_cvt_pk_bf16_f32 v55, v53, v54
    v_lshlrev_b32 v53, 16, v52
    v_and_b32 v54, s23, v52
    v_lshlrev_b32 v56, 16, v55
    v_and_b32 v57, s23, v55
    v_add_f32 v53, v53, v56
    v_add_f32 v54, v54, v57
    v_cvt_pk_bf16_f32 v61, v53, v54

    buffer_store_dwordx2 v[60:61], v10, s[32:35], 0 offen offset:32
conv_done:
    s_endpgm
.globl row0_kernel
.p2align 8
.type row0_kernel,@function
row0_kernel:
    s_cmp_ge_u32 s2, 256
    s_cbranch_scc1 row0_done
    s_load_dwordx2 s[4:5], s[0:1], 0
    s_load_dwordx2 s[6:7], s[0:1], 96
    s_load_dwordx2 s[8:9], s[0:1], 80
    s_mov_b32 s23, 0xffff0000
    s_mov_b32 s24, 0x3ae38e39
    s_mov_b32 s25, 0x3727c5ac
    s_mov_b64 s[26:27], 0xff
    v_lshrrev_b32 v7, 6, v0
    v_and_b32 v2, 63, v0
    s_lshl_b32 s3, s2, 3
    v_add_u32 v1, s3, v7
    v_mul_u32_u24 v3, 1152, v1
    v_lshlrev_b32 v4, 4, v2
    v_add_u32 v3, v3, v4
    v_add_u32 v4, 1024, v3
    v_cmp_gt_u32 vcc, 8, v2
    v_mov_b32 v30, 0
    v_mov_b32 v31, 1.0
    s_nop 1
    v_cndmask_b32 v30, v30, v31, vcc
    s_waitcnt lgkmcnt(0)

    s_mov_b32 s12, s4
    s_mov_b32 s13, s5
    s_mov_b32 s14, 2359296
    s_mov_b32 s15, 0x00020000
    s_mov_b32 s16, s6
    s_mov_b32 s17, s7
    s_mov_b32 s18, 2359296
    s_mov_b32 s19, 0x00020000
    s_add_u32 s28, s6, 50331648
    s_addc_u32 s29, s7, 0
    s_mov_b32 s30, 18874368
    s_mov_b32 s31, 0x00020000
    s_add_u32 s32, s6, 4194304
    s_addc_u32 s33, s7, 0
    s_mov_b32 s34, 2359296
    s_mov_b32 s35, 0x00020000
    s_add_u32 s36, s6, 8388608
    s_addc_u32 s37, s7, 0
    s_mov_b32 s38, 2359296
    s_mov_b32 s39, 0x00020000
    v_mov_b32 v36, 0
    v_mov_b32 v37, 0
    v_mov_b32 v38, 0
    v_mov_b32 v39, 0
    v_mov_b32 v44, 0
    v_mov_b32 v45, 0
    v_mov_b32 v46, 0
    v_mov_b32 v47, 0
    buffer_load_dwordx4 v[32:35], v3, s[12:15], 0 offen

    s_lshr_b32 s3, s2, 2
    s_mul_i32 s3, s3, 36864
    s_and_b32 s46, s2, 3
    s_lshl_b32 s46, s46, 4
    s_add_u32 s3, s3, s46
    v_lshlrev_b32 v52, 6, v0
    v_add_u32 v52, s3, v52
    buffer_load_dwordx4 v[40:43], v52, s[16:19], 0 offen
    v_cmp_gt_u32 vcc, 64, v0
    s_and_saveexec_b64 s[44:45], vcc
    v_add_u32 v53, 32768, v52
    buffer_load_dwordx4 v[44:47], v53, s[16:19], 0 offen
    s_mov_b64 exec, s[44:45]

    s_mov_b64 exec, s[26:27]
    buffer_load_dwordx4 v[36:39], v4, s[12:15], 0 offen
    s_mov_b64 exec, -1
    s_waitcnt vmcnt(0)
    v_lshlrev_b32 v52, 1, v0

    ds_write_b16 v52, v40 offset:0
    ds_write_b16_d16_hi v52, v40 offset:1168

    ds_write_b16 v52, v41 offset:2336
    ds_write_b16_d16_hi v52, v41 offset:3504

    ds_write_b16 v52, v42 offset:4672
    ds_write_b16_d16_hi v52, v42 offset:5840

    ds_write_b16 v52, v43 offset:7008
    ds_write_b16_d16_hi v52, v43 offset:8176

    v_cmp_gt_u32 vcc, 64, v0
    s_and_saveexec_b64 s[44:45], vcc

    ds_write_b16 v52, v44 offset:1024
    ds_write_b16_d16_hi v52, v44 offset:2192

    ds_write_b16 v52, v45 offset:3360
    ds_write_b16_d16_hi v52, v45 offset:4528

    ds_write_b16 v52, v46 offset:5696
    ds_write_b16_d16_hi v52, v46 offset:6864

    ds_write_b16 v52, v47 offset:8032
    ds_write_b16_d16_hi v52, v47 offset:9200

    s_mov_b64 exec, s[44:45]
    v_mul_u32_u24 v52, 1168, v7
    v_lshl_add_u32 v52, v2, 4, v52
    v_mov_b32 v132, 0
    v_mov_b32 v133, 0
    v_mov_b32 v134, 0
    v_mov_b32 v135, 0
    s_waitcnt lgkmcnt(0)
    s_barrier
    ds_read_b128 v[128:131], v52
    s_mov_b64 exec, s[26:27]
    ds_read_b128 v[132:135], v52 offset:1024
    s_mov_b64 exec, -1

    v_lshlrev_b32 v8, 16, v32
    v_and_b32 v9, s23, v32

    v_lshlrev_b32 v10, 16, v33
    v_and_b32 v11, s23, v33

    v_lshlrev_b32 v12, 16, v34
    v_and_b32 v13, s23, v34

    v_lshlrev_b32 v14, 16, v35
    v_and_b32 v15, s23, v35

    v_lshlrev_b32 v16, 16, v36
    v_and_b32 v17, s23, v36

    v_lshlrev_b32 v18, 16, v37
    v_and_b32 v19, s23, v37

    v_lshlrev_b32 v20, 16, v38
    v_and_b32 v21, s23, v38

    v_lshlrev_b32 v22, 16, v39
    v_and_b32 v23, s23, v39

    v_add_f32 v80, v8, v9
    v_add_f32 v80, v80, v10
    v_add_f32 v80, v80, v11
    v_add_f32 v80, v80, v12
    v_add_f32 v80, v80, v13
    v_add_f32 v80, v80, v14
    v_add_f32 v80, v80, v15
    v_add_f32 v80, v80, v16
    v_add_f32 v80, v80, v17
    v_add_f32 v80, v80, v18
    v_add_f32 v80, v80, v19
    v_add_f32 v80, v80, v20
    v_add_f32 v80, v80, v21
    v_add_f32 v80, v80, v22
    v_add_f32 v80, v80, v23
    s_nop 1
    v_add_f32_dpp v81, v80, v80 quad_perm:[1,0,3,2] row_mask:0xf bank_mask:0xf
    v_mov_b32 v80, v81

    s_nop 1
    v_add_f32_dpp v81, v80, v80 quad_perm:[2,3,0,1] row_mask:0xf bank_mask:0xf
    v_mov_b32 v80, v81

    s_nop 1
    v_add_f32_dpp v81, v80, v80 row_half_mirror row_mask:0xf bank_mask:0xf
    v_mov_b32 v80, v81

    s_nop 1
    v_add_f32_dpp v81, v80, v80 row_mirror row_mask:0xf bank_mask:0xf
    v_mov_b32 v80, v81

    s_nop 1
    v_readlane_b32 s40, v80, 0
    v_readlane_b32 s41, v80, 16
    v_readlane_b32 s42, v80, 32
    v_readlane_b32 s43, v80, 48
    s_nop 3
    v_mov_b32 v80, s40
    v_add_f32 v80, s41, v80
    v_add_f32 v80, s42, v80
    v_add_f32 v80, s43, v80

    v_mul_f32 v80, s24, v80

    v_sub_f32 v64, v8, v80
    v_sub_f32 v65, v9, v80
    v_sub_f32 v66, v10, v80
    v_sub_f32 v67, v11, v80
    v_sub_f32 v68, v12, v80
    v_sub_f32 v69, v13, v80
    v_sub_f32 v70, v14, v80
    v_sub_f32 v71, v15, v80
    v_sub_f32 v72, v16, v80
    v_sub_f32 v73, v17, v80
    v_sub_f32 v74, v18, v80
    v_sub_f32 v75, v19, v80
    v_sub_f32 v76, v20, v80
    v_sub_f32 v77, v21, v80
    v_sub_f32 v78, v22, v80
    v_sub_f32 v79, v23, v80
    v_mul_f32 v72, v72, v30
    v_mul_f32 v73, v73, v30
    v_mul_f32 v74, v74, v30
    v_mul_f32 v75, v75, v30
    v_mul_f32 v76, v76, v30
    v_mul_f32 v77, v77, v30
    v_mul_f32 v78, v78, v30
    v_mul_f32 v79, v79, v30
    v_mul_f32 v82, v64, v64
    v_fmac_f32 v82, v65, v65
    v_fmac_f32 v82, v66, v66
    v_fmac_f32 v82, v67, v67
    v_fmac_f32 v82, v68, v68
    v_fmac_f32 v82, v69, v69
    v_fmac_f32 v82, v70, v70
    v_fmac_f32 v82, v71, v71
    v_fmac_f32 v82, v72, v72
    v_fmac_f32 v82, v73, v73
    v_fmac_f32 v82, v74, v74
    v_fmac_f32 v82, v75, v75
    v_fmac_f32 v82, v76, v76
    v_fmac_f32 v82, v77, v77
    v_fmac_f32 v82, v78, v78
    v_fmac_f32 v82, v79, v79
    s_nop 1
    v_add_f32_dpp v83, v82, v82 quad_perm:[1,0,3,2] row_mask:0xf bank_mask:0xf
    v_mov_b32 v82, v83

    s_nop 1
    v_add_f32_dpp v83, v82, v82 quad_perm:[2,3,0,1] row_mask:0xf bank_mask:0xf
    v_mov_b32 v82, v83

    s_nop 1
    v_add_f32_dpp v83, v82, v82 row_half_mirror row_mask:0xf bank_mask:0xf
    v_mov_b32 v82, v83

    s_nop 1
    v_add_f32_dpp v83, v82, v82 row_mirror row_mask:0xf bank_mask:0xf
    v_mov_b32 v82, v83

    s_nop 1
    v_readlane_b32 s40, v82, 0
    v_readlane_b32 s41, v82, 16
    v_readlane_b32 s42, v82, 32
    v_readlane_b32 s43, v82, 48
    s_nop 3
    v_mov_b32 v82, s40
    v_add_f32 v82, s41, v82
    v_add_f32 v82, s42, v82
    v_add_f32 v82, s43, v82

    v_mul_f32 v82, s24, v82
    v_cvt_pk_bf16_f32 v83, v80, v82
    v_lshlrev_b32 v80, 16, v83
    v_and_b32 v82, s23, v83
    v_add_f32 v82, s25, v82
    v_cvt_pk_bf16_f32 v82, v82, v82
    v_lshlrev_b32 v82, 16, v82
    v_sqrt_f32 v82, v82
    s_nop 0
    v_cvt_pk_bf16_f32 v82, v82, v82
    v_lshlrev_b32 v82, 16, v82
    v_rcp_f32 v84, v82
    s_nop 0

    v_sub_f32 v64, v8, v80
    v_sub_f32 v65, v9, v80
    v_cvt_pk_bf16_f32 v85, v64, v65
    v_lshlrev_b32 v64, 16, v85
    v_and_b32 v65, s23, v85
    v_mul_f32 v86, v64, v84
    v_mul_f32 v87, v65, v84
    v_fma_f32 v64, -v86, v82, v64
    v_fma_f32 v65, -v87, v82, v65
    v_fmac_f32 v86, v64, v84
    v_fmac_f32 v87, v65, v84
    v_cvt_pk_bf16_f32 v85, v86, v87
    v_lshlrev_b32 v64, 16, v85
    v_and_b32 v65, s23, v85

    v_sub_f32 v66, v10, v80
    v_sub_f32 v67, v11, v80
    v_cvt_pk_bf16_f32 v85, v66, v67
    v_lshlrev_b32 v66, 16, v85
    v_and_b32 v67, s23, v85
    v_mul_f32 v86, v66, v84
    v_mul_f32 v87, v67, v84
    v_fma_f32 v66, -v86, v82, v66
    v_fma_f32 v67, -v87, v82, v67
    v_fmac_f32 v86, v66, v84
    v_fmac_f32 v87, v67, v84
    v_cvt_pk_bf16_f32 v85, v86, v87
    v_lshlrev_b32 v66, 16, v85
    v_and_b32 v67, s23, v85

    v_sub_f32 v68, v12, v80
    v_sub_f32 v69, v13, v80
    v_cvt_pk_bf16_f32 v85, v68, v69
    v_lshlrev_b32 v68, 16, v85
    v_and_b32 v69, s23, v85
    v_mul_f32 v86, v68, v84
    v_mul_f32 v87, v69, v84
    v_fma_f32 v68, -v86, v82, v68
    v_fma_f32 v69, -v87, v82, v69
    v_fmac_f32 v86, v68, v84
    v_fmac_f32 v87, v69, v84
    v_cvt_pk_bf16_f32 v85, v86, v87
    v_lshlrev_b32 v68, 16, v85
    v_and_b32 v69, s23, v85

    v_sub_f32 v70, v14, v80
    v_sub_f32 v71, v15, v80
    v_cvt_pk_bf16_f32 v85, v70, v71
    v_lshlrev_b32 v70, 16, v85
    v_and_b32 v71, s23, v85
    v_mul_f32 v86, v70, v84
    v_mul_f32 v87, v71, v84
    v_fma_f32 v70, -v86, v82, v70
    v_fma_f32 v71, -v87, v82, v71
    v_fmac_f32 v86, v70, v84
    v_fmac_f32 v87, v71, v84
    v_cvt_pk_bf16_f32 v85, v86, v87
    v_lshlrev_b32 v70, 16, v85
    v_and_b32 v71, s23, v85

    v_sub_f32 v72, v16, v80
    v_sub_f32 v73, v17, v80
    v_cvt_pk_bf16_f32 v85, v72, v73
    v_lshlrev_b32 v72, 16, v85
    v_and_b32 v73, s23, v85
    v_mul_f32 v86, v72, v84
    v_mul_f32 v87, v73, v84
    v_fma_f32 v72, -v86, v82, v72
    v_fma_f32 v73, -v87, v82, v73
    v_fmac_f32 v86, v72, v84
    v_fmac_f32 v87, v73, v84
    v_cvt_pk_bf16_f32 v85, v86, v87
    v_lshlrev_b32 v72, 16, v85
    v_and_b32 v73, s23, v85

    v_sub_f32 v74, v18, v80
    v_sub_f32 v75, v19, v80
    v_cvt_pk_bf16_f32 v85, v74, v75
    v_lshlrev_b32 v74, 16, v85
    v_and_b32 v75, s23, v85
    v_mul_f32 v86, v74, v84
    v_mul_f32 v87, v75, v84
    v_fma_f32 v74, -v86, v82, v74
    v_fma_f32 v75, -v87, v82, v75
    v_fmac_f32 v86, v74, v84
    v_fmac_f32 v87, v75, v84
    v_cvt_pk_bf16_f32 v85, v86, v87
    v_lshlrev_b32 v74, 16, v85
    v_and_b32 v75, s23, v85

    v_sub_f32 v76, v20, v80
    v_sub_f32 v77, v21, v80
    v_cvt_pk_bf16_f32 v85, v76, v77
    v_lshlrev_b32 v76, 16, v85
    v_and_b32 v77, s23, v85
    v_mul_f32 v86, v76, v84
    v_mul_f32 v87, v77, v84
    v_fma_f32 v76, -v86, v82, v76
    v_fma_f32 v77, -v87, v82, v77
    v_fmac_f32 v86, v76, v84
    v_fmac_f32 v87, v77, v84
    v_cvt_pk_bf16_f32 v85, v86, v87
    v_lshlrev_b32 v76, 16, v85
    v_and_b32 v77, s23, v85

    v_sub_f32 v78, v22, v80
    v_sub_f32 v79, v23, v80
    v_cvt_pk_bf16_f32 v85, v78, v79
    v_lshlrev_b32 v78, 16, v85
    v_and_b32 v79, s23, v85
    v_mul_f32 v86, v78, v84
    v_mul_f32 v87, v79, v84
    v_fma_f32 v78, -v86, v82, v78
    v_fma_f32 v79, -v87, v82, v79
    v_fmac_f32 v86, v78, v84
    v_fmac_f32 v87, v79, v84
    v_cvt_pk_bf16_f32 v85, v86, v87
    v_lshlrev_b32 v78, 16, v85
    v_and_b32 v79, s23, v85

    s_waitcnt lgkmcnt(0)
    v_lshlrev_b32 v96, 16, v128
    v_and_b32 v97, s23, v128

    v_lshlrev_b32 v98, 16, v129
    v_and_b32 v99, s23, v129

    v_lshlrev_b32 v100, 16, v130
    v_and_b32 v101, s23, v130

    v_lshlrev_b32 v102, 16, v131
    v_and_b32 v103, s23, v131

    v_lshlrev_b32 v104, 16, v132
    v_and_b32 v105, s23, v132

    v_lshlrev_b32 v106, 16, v133
    v_and_b32 v107, s23, v133

    v_lshlrev_b32 v108, 16, v134
    v_and_b32 v109, s23, v134

    v_lshlrev_b32 v110, 16, v135
    v_and_b32 v111, s23, v135

    v_mul_f32 v49, v64, v96
    v_mul_f32 v50, v65, v97
    v_cvt_pk_bf16_f32 v48, v49, v50
    v_lshlrev_b32 v49, 16, v48
    v_and_b32 v50, s23, v48
    v_add_f32 v49, v49, v8
    v_add_f32 v50, v50, v9
    v_cvt_pk_bf16_f32 v48, v49, v50
    v_lshlrev_b32 v8, 16, v48
    v_and_b32 v9, s23, v48

    v_mul_f32 v49, v66, v98
    v_mul_f32 v50, v67, v99
    v_cvt_pk_bf16_f32 v48, v49, v50
    v_lshlrev_b32 v49, 16, v48
    v_and_b32 v50, s23, v48
    v_add_f32 v49, v49, v10
    v_add_f32 v50, v50, v11
    v_cvt_pk_bf16_f32 v48, v49, v50
    v_lshlrev_b32 v10, 16, v48
    v_and_b32 v11, s23, v48

    v_mul_f32 v49, v68, v100
    v_mul_f32 v50, v69, v101
    v_cvt_pk_bf16_f32 v48, v49, v50
    v_lshlrev_b32 v49, 16, v48
    v_and_b32 v50, s23, v48
    v_add_f32 v49, v49, v12
    v_add_f32 v50, v50, v13
    v_cvt_pk_bf16_f32 v48, v49, v50
    v_lshlrev_b32 v12, 16, v48
    v_and_b32 v13, s23, v48

    v_mul_f32 v49, v70, v102
    v_mul_f32 v50, v71, v103
    v_cvt_pk_bf16_f32 v48, v49, v50
    v_lshlrev_b32 v49, 16, v48
    v_and_b32 v50, s23, v48
    v_add_f32 v49, v49, v14
    v_add_f32 v50, v50, v15
    v_cvt_pk_bf16_f32 v48, v49, v50
    v_lshlrev_b32 v14, 16, v48
    v_and_b32 v15, s23, v48

    v_mul_f32 v49, v72, v104
    v_mul_f32 v50, v73, v105
    v_cvt_pk_bf16_f32 v48, v49, v50
    v_lshlrev_b32 v49, 16, v48
    v_and_b32 v50, s23, v48
    v_add_f32 v49, v49, v16
    v_add_f32 v50, v50, v17
    v_cvt_pk_bf16_f32 v48, v49, v50
    v_lshlrev_b32 v16, 16, v48
    v_and_b32 v17, s23, v48

    v_mul_f32 v49, v74, v106
    v_mul_f32 v50, v75, v107
    v_cvt_pk_bf16_f32 v48, v49, v50
    v_lshlrev_b32 v49, 16, v48
    v_and_b32 v50, s23, v48
    v_add_f32 v49, v49, v18
    v_add_f32 v50, v50, v19
    v_cvt_pk_bf16_f32 v48, v49, v50
    v_lshlrev_b32 v18, 16, v48
    v_and_b32 v19, s23, v48

    v_mul_f32 v49, v76, v108
    v_mul_f32 v50, v77, v109
    v_cvt_pk_bf16_f32 v48, v49, v50
    v_lshlrev_b32 v49, 16, v48
    v_and_b32 v50, s23, v48
    v_add_f32 v49, v49, v20
    v_add_f32 v50, v50, v21
    v_cvt_pk_bf16_f32 v48, v49, v50
    v_lshlrev_b32 v20, 16, v48
    v_and_b32 v21, s23, v48

    v_mul_f32 v49, v78, v110
    v_mul_f32 v50, v79, v111
    v_cvt_pk_bf16_f32 v48, v49, v50
    v_lshlrev_b32 v49, 16, v48
    v_and_b32 v50, s23, v48
    v_add_f32 v49, v49, v22
    v_add_f32 v50, v50, v23
    v_cvt_pk_bf16_f32 v48, v49, v50
    v_lshlrev_b32 v22, 16, v48
    v_and_b32 v23, s23, v48

    v_cvt_pk_bf16_f32 v48, v8, v9
    v_cvt_pk_bf16_f32 v49, v10, v11
    v_cvt_pk_bf16_f32 v50, v12, v13
    v_cvt_pk_bf16_f32 v51, v14, v15
    v_cvt_pk_bf16_f32 v52, v16, v17
    v_cvt_pk_bf16_f32 v53, v18, v19
    v_cvt_pk_bf16_f32 v54, v20, v21
    v_cvt_pk_bf16_f32 v55, v22, v23
    buffer_store_dwordx4 v[48:51], v3, s[32:35], 0 offen
    s_mov_b64 exec, s[26:27]
    buffer_store_dwordx4 v[52:55], v4, s[32:35], 0 offen
    s_mov_b64 exec, -1

    v_add_f32 v80, v8, v9
    v_add_f32 v80, v80, v10
    v_add_f32 v80, v80, v11
    v_add_f32 v80, v80, v12
    v_add_f32 v80, v80, v13
    v_add_f32 v80, v80, v14
    v_add_f32 v80, v80, v15
    v_add_f32 v80, v80, v16
    v_add_f32 v80, v80, v17
    v_add_f32 v80, v80, v18
    v_add_f32 v80, v80, v19
    v_add_f32 v80, v80, v20
    v_add_f32 v80, v80, v21
    v_add_f32 v80, v80, v22
    v_add_f32 v80, v80, v23
    s_nop 1
    v_add_f32_dpp v81, v80, v80 quad_perm:[1,0,3,2] row_mask:0xf bank_mask:0xf
    v_mov_b32 v80, v81

    s_nop 1
    v_add_f32_dpp v81, v80, v80 quad_perm:[2,3,0,1] row_mask:0xf bank_mask:0xf
    v_mov_b32 v80, v81

    s_nop 1
    v_add_f32_dpp v81, v80, v80 row_half_mirror row_mask:0xf bank_mask:0xf
    v_mov_b32 v80, v81

    s_nop 1
    v_add_f32_dpp v81, v80, v80 row_mirror row_mask:0xf bank_mask:0xf
    v_mov_b32 v80, v81

    s_nop 1
    v_readlane_b32 s40, v80, 0
    v_readlane_b32 s41, v80, 16
    v_readlane_b32 s42, v80, 32
    v_readlane_b32 s43, v80, 48
    s_nop 3
    v_mov_b32 v80, s40
    v_add_f32 v80, s41, v80
    v_add_f32 v80, s42, v80
    v_add_f32 v80, s43, v80

    v_mul_f32 v80, s24, v80

    v_sub_f32 v64, v8, v80
    v_sub_f32 v65, v9, v80
    v_sub_f32 v66, v10, v80
    v_sub_f32 v67, v11, v80
    v_sub_f32 v68, v12, v80
    v_sub_f32 v69, v13, v80
    v_sub_f32 v70, v14, v80
    v_sub_f32 v71, v15, v80
    v_sub_f32 v72, v16, v80
    v_sub_f32 v73, v17, v80
    v_sub_f32 v74, v18, v80
    v_sub_f32 v75, v19, v80
    v_sub_f32 v76, v20, v80
    v_sub_f32 v77, v21, v80
    v_sub_f32 v78, v22, v80
    v_sub_f32 v79, v23, v80
    v_mul_f32 v72, v72, v30
    v_mul_f32 v73, v73, v30
    v_mul_f32 v74, v74, v30
    v_mul_f32 v75, v75, v30
    v_mul_f32 v76, v76, v30
    v_mul_f32 v77, v77, v30
    v_mul_f32 v78, v78, v30
    v_mul_f32 v79, v79, v30
    v_mul_f32 v82, v64, v64
    v_fmac_f32 v82, v65, v65
    v_fmac_f32 v82, v66, v66
    v_fmac_f32 v82, v67, v67
    v_fmac_f32 v82, v68, v68
    v_fmac_f32 v82, v69, v69
    v_fmac_f32 v82, v70, v70
    v_fmac_f32 v82, v71, v71
    v_fmac_f32 v82, v72, v72
    v_fmac_f32 v82, v73, v73
    v_fmac_f32 v82, v74, v74
    v_fmac_f32 v82, v75, v75
    v_fmac_f32 v82, v76, v76
    v_fmac_f32 v82, v77, v77
    v_fmac_f32 v82, v78, v78
    v_fmac_f32 v82, v79, v79
    s_nop 1
    v_add_f32_dpp v83, v82, v82 quad_perm:[1,0,3,2] row_mask:0xf bank_mask:0xf
    v_mov_b32 v82, v83

    s_nop 1
    v_add_f32_dpp v83, v82, v82 quad_perm:[2,3,0,1] row_mask:0xf bank_mask:0xf
    v_mov_b32 v82, v83

    s_nop 1
    v_add_f32_dpp v83, v82, v82 row_half_mirror row_mask:0xf bank_mask:0xf
    v_mov_b32 v82, v83

    s_nop 1
    v_add_f32_dpp v83, v82, v82 row_mirror row_mask:0xf bank_mask:0xf
    v_mov_b32 v82, v83

    s_nop 1
    v_readlane_b32 s40, v82, 0
    v_readlane_b32 s41, v82, 16
    v_readlane_b32 s42, v82, 32
    v_readlane_b32 s43, v82, 48
    s_nop 3
    v_mov_b32 v82, s40
    v_add_f32 v82, s41, v82
    v_add_f32 v82, s42, v82
    v_add_f32 v82, s43, v82

    v_mul_f32 v82, s24, v82
    v_cvt_pk_bf16_f32 v83, v80, v82
    v_lshlrev_b32 v80, 16, v83
    v_and_b32 v82, s23, v83
    v_add_f32 v82, s25, v82
    v_cvt_pk_bf16_f32 v82, v82, v82
    v_lshlrev_b32 v82, 16, v82
    v_sqrt_f32 v82, v82
    s_nop 0
    v_cvt_pk_bf16_f32 v82, v82, v82
    v_lshlrev_b32 v82, 16, v82
    v_rcp_f32 v84, v82
    s_nop 0

    v_sub_f32 v64, v8, v80
    v_sub_f32 v65, v9, v80
    v_cvt_pk_bf16_f32 v85, v64, v65
    v_lshlrev_b32 v64, 16, v85
    v_and_b32 v65, s23, v85
    v_mul_f32 v86, v64, v84
    v_mul_f32 v87, v65, v84
    v_fma_f32 v64, -v86, v82, v64
    v_fma_f32 v65, -v87, v82, v65
    v_fmac_f32 v86, v64, v84
    v_fmac_f32 v87, v65, v84
    v_cvt_pk_bf16_f32 v85, v86, v87
    v_lshlrev_b32 v64, 16, v85
    v_and_b32 v65, s23, v85

    v_sub_f32 v66, v10, v80
    v_sub_f32 v67, v11, v80
    v_cvt_pk_bf16_f32 v85, v66, v67
    v_lshlrev_b32 v66, 16, v85
    v_and_b32 v67, s23, v85
    v_mul_f32 v86, v66, v84
    v_mul_f32 v87, v67, v84
    v_fma_f32 v66, -v86, v82, v66
    v_fma_f32 v67, -v87, v82, v67
    v_fmac_f32 v86, v66, v84
    v_fmac_f32 v87, v67, v84
    v_cvt_pk_bf16_f32 v85, v86, v87
    v_lshlrev_b32 v66, 16, v85
    v_and_b32 v67, s23, v85

    v_sub_f32 v68, v12, v80
    v_sub_f32 v69, v13, v80
    v_cvt_pk_bf16_f32 v85, v68, v69
    v_lshlrev_b32 v68, 16, v85
    v_and_b32 v69, s23, v85
    v_mul_f32 v86, v68, v84
    v_mul_f32 v87, v69, v84
    v_fma_f32 v68, -v86, v82, v68
    v_fma_f32 v69, -v87, v82, v69
    v_fmac_f32 v86, v68, v84
    v_fmac_f32 v87, v69, v84
    v_cvt_pk_bf16_f32 v85, v86, v87
    v_lshlrev_b32 v68, 16, v85
    v_and_b32 v69, s23, v85

    v_sub_f32 v70, v14, v80
    v_sub_f32 v71, v15, v80
    v_cvt_pk_bf16_f32 v85, v70, v71
    v_lshlrev_b32 v70, 16, v85
    v_and_b32 v71, s23, v85
    v_mul_f32 v86, v70, v84
    v_mul_f32 v87, v71, v84
    v_fma_f32 v70, -v86, v82, v70
    v_fma_f32 v71, -v87, v82, v71
    v_fmac_f32 v86, v70, v84
    v_fmac_f32 v87, v71, v84
    v_cvt_pk_bf16_f32 v85, v86, v87
    v_lshlrev_b32 v70, 16, v85
    v_and_b32 v71, s23, v85

    v_sub_f32 v72, v16, v80
    v_sub_f32 v73, v17, v80
    v_cvt_pk_bf16_f32 v85, v72, v73
    v_lshlrev_b32 v72, 16, v85
    v_and_b32 v73, s23, v85
    v_mul_f32 v86, v72, v84
    v_mul_f32 v87, v73, v84
    v_fma_f32 v72, -v86, v82, v72
    v_fma_f32 v73, -v87, v82, v73
    v_fmac_f32 v86, v72, v84
    v_fmac_f32 v87, v73, v84
    v_cvt_pk_bf16_f32 v85, v86, v87
    v_lshlrev_b32 v72, 16, v85
    v_and_b32 v73, s23, v85

    v_sub_f32 v74, v18, v80
    v_sub_f32 v75, v19, v80
    v_cvt_pk_bf16_f32 v85, v74, v75
    v_lshlrev_b32 v74, 16, v85
    v_and_b32 v75, s23, v85
    v_mul_f32 v86, v74, v84
    v_mul_f32 v87, v75, v84
    v_fma_f32 v74, -v86, v82, v74
    v_fma_f32 v75, -v87, v82, v75
    v_fmac_f32 v86, v74, v84
    v_fmac_f32 v87, v75, v84
    v_cvt_pk_bf16_f32 v85, v86, v87
    v_lshlrev_b32 v74, 16, v85
    v_and_b32 v75, s23, v85

    v_sub_f32 v76, v20, v80
    v_sub_f32 v77, v21, v80
    v_cvt_pk_bf16_f32 v85, v76, v77
    v_lshlrev_b32 v76, 16, v85
    v_and_b32 v77, s23, v85
    v_mul_f32 v86, v76, v84
    v_mul_f32 v87, v77, v84
    v_fma_f32 v76, -v86, v82, v76
    v_fma_f32 v77, -v87, v82, v77
    v_fmac_f32 v86, v76, v84
    v_fmac_f32 v87, v77, v84
    v_cvt_pk_bf16_f32 v85, v86, v87
    v_lshlrev_b32 v76, 16, v85
    v_and_b32 v77, s23, v85

    v_sub_f32 v78, v22, v80
    v_sub_f32 v79, v23, v80
    v_cvt_pk_bf16_f32 v85, v78, v79
    v_lshlrev_b32 v78, 16, v85
    v_and_b32 v79, s23, v85
    v_mul_f32 v86, v78, v84
    v_mul_f32 v87, v79, v84
    v_fma_f32 v78, -v86, v82, v78
    v_fma_f32 v79, -v87, v82, v79
    v_fmac_f32 v86, v78, v84
    v_fmac_f32 v87, v79, v84
    v_cvt_pk_bf16_f32 v85, v86, v87
    v_lshlrev_b32 v78, 16, v85
    v_and_b32 v79, s23, v85

    v_cvt_pk_bf16_f32 v48, v64, v65
    v_cvt_pk_bf16_f32 v49, v66, v67
    v_cvt_pk_bf16_f32 v50, v68, v69
    v_cvt_pk_bf16_f32 v51, v70, v71
    v_cvt_pk_bf16_f32 v52, v72, v73
    v_cvt_pk_bf16_f32 v53, v74, v75
    v_cvt_pk_bf16_f32 v54, v76, v77
    v_cvt_pk_bf16_f32 v55, v78, v79
    buffer_store_dwordx4 v[48:51], v3, s[36:39], 0 offen
    s_mov_b64 exec, s[26:27]
    buffer_store_dwordx4 v[52:55], v4, s[36:39], 0 offen
    s_mov_b64 exec, -1

row0_done:
    s_endpgm
.globl row1_kernel
.p2align 8
.type row1_kernel,@function
row1_kernel:
    s_cmp_ge_u32 s2, 256
    s_cbranch_scc1 row1_done
    s_load_dwordx2 s[4:5], s[0:1], 0
    s_load_dwordx2 s[6:7], s[0:1], 96
    s_load_dwordx2 s[8:9], s[0:1], 80
    s_mov_b32 s23, 0xffff0000
    s_mov_b32 s24, 0x3ae38e39
    s_mov_b32 s25, 0x3727c5ac
    s_mov_b64 s[26:27], 0xff
    v_lshrrev_b32 v7, 6, v0
    v_and_b32 v2, 63, v0
    s_lshl_b32 s3, s2, 3
    v_add_u32 v1, s3, v7
    v_mul_u32_u24 v3, 1152, v1
    v_lshlrev_b32 v4, 4, v2
    v_add_u32 v3, v3, v4
    v_add_u32 v4, 1024, v3
    v_cmp_gt_u32 vcc, 8, v2
    v_mov_b32 v30, 0
    v_mov_b32 v31, 1.0
    s_nop 1
    v_cndmask_b32 v30, v30, v31, vcc
    s_waitcnt lgkmcnt(0)

    s_add_u32 s12, s6, 4194304
    s_addc_u32 s13, s7, 0
    s_mov_b32 s14, 2359296
    s_mov_b32 s15, 0x00020000
    s_mov_b32 s16, s6
    s_mov_b32 s17, s7
    s_mov_b32 s18, 2359296
    s_mov_b32 s19, 0x00020000
    s_add_u32 s28, s6, 50331648
    s_addc_u32 s29, s7, 0
    s_mov_b32 s30, 18874368
    s_mov_b32 s31, 0x00020000
    s_add_u32 s32, s6, 12582912
    s_addc_u32 s33, s7, 0
    s_mov_b32 s34, 2359296
    s_mov_b32 s35, 0x00020000
    s_add_u32 s36, s6, 8388608
    s_addc_u32 s37, s7, 0
    s_mov_b32 s38, 2359296
    s_mov_b32 s39, 0x00020000
    v_mov_b32 v36, 0
    v_mov_b32 v37, 0
    v_mov_b32 v38, 0
    v_mov_b32 v39, 0
    v_mov_b32 v44, 0
    v_mov_b32 v45, 0
    v_mov_b32 v46, 0
    v_mov_b32 v47, 0
    buffer_load_dwordx4 v[32:35], v3, s[12:15], 0 offen

    s_lshr_b32 s3, s2, 2
    s_mul_i32 s3, s3, 36864
    s_and_b32 s46, s2, 3
    s_lshl_b32 s46, s46, 4
    s_add_u32 s3, s3, s46
    v_lshlrev_b32 v52, 6, v0
    v_add_u32 v52, s3, v52
    buffer_load_dwordx4 v[40:43], v52, s[16:19], 0 offen
    v_cmp_gt_u32 vcc, 64, v0
    s_and_saveexec_b64 s[44:45], vcc
    v_add_u32 v53, 32768, v52
    buffer_load_dwordx4 v[44:47], v53, s[16:19], 0 offen
    s_mov_b64 exec, s[44:45]

    s_mov_b64 exec, s[26:27]
    buffer_load_dwordx4 v[36:39], v4, s[12:15], 0 offen
    s_mov_b64 exec, -1
    v_lshlrev_b32 v5, 1, v3
    v_add_u32 v6, 2048, v5

    v_mov_b32 v64, 0
    v_mov_b32 v65, 0
    v_mov_b32 v66, 0
    v_mov_b32 v67, 0
    v_mov_b32 v68, 0
    v_mov_b32 v69, 0
    v_mov_b32 v70, 0
    v_mov_b32 v71, 0
    v_mov_b32 v72, 0
    v_mov_b32 v73, 0
    v_mov_b32 v74, 0
    v_mov_b32 v75, 0
    v_mov_b32 v76, 0
    v_mov_b32 v77, 0
    v_mov_b32 v78, 0
    v_mov_b32 v79, 0
    v_mov_b32 v80, 0
    v_mov_b32 v81, 0
    v_mov_b32 v82, 0
    v_mov_b32 v83, 0
    v_mov_b32 v84, 0
    v_mov_b32 v85, 0
    v_mov_b32 v86, 0
    v_mov_b32 v87, 0
    v_mov_b32 v88, 0
    v_mov_b32 v89, 0
    v_mov_b32 v90, 0
    v_mov_b32 v91, 0
    v_mov_b32 v92, 0
    v_mov_b32 v93, 0
    v_mov_b32 v94, 0
    v_mov_b32 v95, 0
    v_mov_b32 v96, 0
    v_mov_b32 v97, 0
    v_mov_b32 v98, 0
    v_mov_b32 v99, 0
    v_mov_b32 v100, 0
    v_mov_b32 v101, 0
    v_mov_b32 v102, 0
    v_mov_b32 v103, 0
    v_mov_b32 v104, 0
    v_mov_b32 v105, 0
    v_mov_b32 v106, 0
    v_mov_b32 v107, 0
    v_mov_b32 v108, 0
    v_mov_b32 v109, 0
    v_mov_b32 v110, 0
    v_mov_b32 v111, 0
    v_mov_b32 v112, 0
    v_mov_b32 v113, 0
    v_mov_b32 v114, 0
    v_mov_b32 v115, 0
    v_mov_b32 v116, 0
    v_mov_b32 v117, 0
    v_mov_b32 v118, 0
    v_mov_b32 v119, 0
    v_mov_b32 v120, 0
    v_mov_b32 v121, 0
    v_mov_b32 v122, 0
    v_mov_b32 v123, 0
    v_mov_b32 v124, 0
    v_mov_b32 v125, 0
    v_mov_b32 v126, 0
    v_mov_b32 v127, 0
    s_mov_b32 s3, 0
    buffer_load_dwordx4 v[64:67], v5, s[28:31], s3 offen
    buffer_load_dwordx4 v[68:71], v5, s[28:31], s3 offen offset:16

    s_mov_b32 s3, 4718592
    buffer_load_dwordx4 v[80:83], v5, s[28:31], s3 offen
    buffer_load_dwordx4 v[84:87], v5, s[28:31], s3 offen offset:16

    s_mov_b32 s3, 9437184
    buffer_load_dwordx4 v[96:99], v5, s[28:31], s3 offen
    buffer_load_dwordx4 v[100:103], v5, s[28:31], s3 offen offset:16

    s_mov_b32 s3, 14155776
    buffer_load_dwordx4 v[112:115], v5, s[28:31], s3 offen
    buffer_load_dwordx4 v[116:119], v5, s[28:31], s3 offen offset:16

    s_mov_b64 exec, s[26:27]
    s_mov_b32 s3, 0
    buffer_load_dwordx4 v[72:75], v6, s[28:31], s3 offen
    buffer_load_dwordx4 v[76:79], v6, s[28:31], s3 offen offset:16

    s_mov_b32 s3, 4718592
    buffer_load_dwordx4 v[88:91], v6, s[28:31], s3 offen
    buffer_load_dwordx4 v[92:95], v6, s[28:31], s3 offen offset:16

    s_mov_b32 s3, 9437184
    buffer_load_dwordx4 v[104:107], v6, s[28:31], s3 offen
    buffer_load_dwordx4 v[108:111], v6, s[28:31], s3 offen offset:16

    s_mov_b32 s3, 14155776
    buffer_load_dwordx4 v[120:123], v6, s[28:31], s3 offen
    buffer_load_dwordx4 v[124:127], v6, s[28:31], s3 offen offset:16

    s_mov_b64 exec, -1
    s_waitcnt vmcnt(0)
    v_lshlrev_b32 v52, 1, v0

    ds_write_b16 v52, v40 offset:0
    ds_write_b16_d16_hi v52, v40 offset:1168

    ds_write_b16 v52, v41 offset:2336
    ds_write_b16_d16_hi v52, v41 offset:3504

    ds_write_b16 v52, v42 offset:4672
    ds_write_b16_d16_hi v52, v42 offset:5840

    ds_write_b16 v52, v43 offset:7008
    ds_write_b16_d16_hi v52, v43 offset:8176

    v_cmp_gt_u32 vcc, 64, v0
    s_and_saveexec_b64 s[44:45], vcc

    ds_write_b16 v52, v44 offset:1024
    ds_write_b16_d16_hi v52, v44 offset:2192

    ds_write_b16 v52, v45 offset:3360
    ds_write_b16_d16_hi v52, v45 offset:4528

    ds_write_b16 v52, v46 offset:5696
    ds_write_b16_d16_hi v52, v46 offset:6864

    ds_write_b16 v52, v47 offset:8032
    ds_write_b16_d16_hi v52, v47 offset:9200

    s_mov_b64 exec, s[44:45]
    v_mul_u32_u24 v52, 1168, v7
    v_lshl_add_u32 v52, v2, 4, v52
    v_mov_b32 v132, 0
    v_mov_b32 v133, 0
    v_mov_b32 v134, 0
    v_mov_b32 v135, 0
    s_waitcnt lgkmcnt(0)
    s_barrier
    ds_read_b128 v[128:131], v52
    s_mov_b64 exec, s[26:27]
    ds_read_b128 v[132:135], v52 offset:1024
    s_mov_b64 exec, -1

    v_lshlrev_b32 v8, 16, v32
    v_and_b32 v9, s23, v32

    v_lshlrev_b32 v10, 16, v33
    v_and_b32 v11, s23, v33

    v_lshlrev_b32 v12, 16, v34
    v_and_b32 v13, s23, v34

    v_lshlrev_b32 v14, 16, v35
    v_and_b32 v15, s23, v35

    v_lshlrev_b32 v16, 16, v36
    v_and_b32 v17, s23, v36

    v_lshlrev_b32 v18, 16, v37
    v_and_b32 v19, s23, v37

    v_lshlrev_b32 v20, 16, v38
    v_and_b32 v21, s23, v38

    v_lshlrev_b32 v22, 16, v39
    v_and_b32 v23, s23, v39

    v_add_f32 v64, v64, v80
    v_add_f32 v96, v96, v112
    v_add_f32 v64, v64, v96

    v_add_f32 v65, v65, v81
    v_add_f32 v97, v97, v113
    v_add_f32 v65, v65, v97

    v_add_f32 v66, v66, v82
    v_add_f32 v98, v98, v114
    v_add_f32 v66, v66, v98

    v_add_f32 v67, v67, v83
    v_add_f32 v99, v99, v115
    v_add_f32 v67, v67, v99

    v_add_f32 v68, v68, v84
    v_add_f32 v100, v100, v116
    v_add_f32 v68, v68, v100

    v_add_f32 v69, v69, v85
    v_add_f32 v101, v101, v117
    v_add_f32 v69, v69, v101

    v_add_f32 v70, v70, v86
    v_add_f32 v102, v102, v118
    v_add_f32 v70, v70, v102

    v_add_f32 v71, v71, v87
    v_add_f32 v103, v103, v119
    v_add_f32 v71, v71, v103

    v_add_f32 v72, v72, v88
    v_add_f32 v104, v104, v120
    v_add_f32 v72, v72, v104

    v_add_f32 v73, v73, v89
    v_add_f32 v105, v105, v121
    v_add_f32 v73, v73, v105

    v_add_f32 v74, v74, v90
    v_add_f32 v106, v106, v122
    v_add_f32 v74, v74, v106

    v_add_f32 v75, v75, v91
    v_add_f32 v107, v107, v123
    v_add_f32 v75, v75, v107

    v_add_f32 v76, v76, v92
    v_add_f32 v108, v108, v124
    v_add_f32 v76, v76, v108

    v_add_f32 v77, v77, v93
    v_add_f32 v109, v109, v125
    v_add_f32 v77, v77, v109

    v_add_f32 v78, v78, v94
    v_add_f32 v110, v110, v126
    v_add_f32 v78, v78, v110

    v_add_f32 v79, v79, v95
    v_add_f32 v111, v111, v127
    v_add_f32 v79, v79, v111

    v_cvt_pk_bf16_f32 v48, v64, v65
    v_lshlrev_b32 v49, 16, v48
    v_and_b32 v50, s23, v48
    v_add_f32 v49, v49, v8
    v_add_f32 v50, v50, v9
    v_cvt_pk_bf16_f32 v48, v49, v50
    v_lshlrev_b32 v8, 16, v48
    v_and_b32 v9, s23, v48

    v_cvt_pk_bf16_f32 v48, v66, v67
    v_lshlrev_b32 v49, 16, v48
    v_and_b32 v50, s23, v48
    v_add_f32 v49, v49, v10
    v_add_f32 v50, v50, v11
    v_cvt_pk_bf16_f32 v48, v49, v50
    v_lshlrev_b32 v10, 16, v48
    v_and_b32 v11, s23, v48

    v_cvt_pk_bf16_f32 v48, v68, v69
    v_lshlrev_b32 v49, 16, v48
    v_and_b32 v50, s23, v48
    v_add_f32 v49, v49, v12
    v_add_f32 v50, v50, v13
    v_cvt_pk_bf16_f32 v48, v49, v50
    v_lshlrev_b32 v12, 16, v48
    v_and_b32 v13, s23, v48

    v_cvt_pk_bf16_f32 v48, v70, v71
    v_lshlrev_b32 v49, 16, v48
    v_and_b32 v50, s23, v48
    v_add_f32 v49, v49, v14
    v_add_f32 v50, v50, v15
    v_cvt_pk_bf16_f32 v48, v49, v50
    v_lshlrev_b32 v14, 16, v48
    v_and_b32 v15, s23, v48

    v_cvt_pk_bf16_f32 v48, v72, v73
    v_lshlrev_b32 v49, 16, v48
    v_and_b32 v50, s23, v48
    v_add_f32 v49, v49, v16
    v_add_f32 v50, v50, v17
    v_cvt_pk_bf16_f32 v48, v49, v50
    v_lshlrev_b32 v16, 16, v48
    v_and_b32 v17, s23, v48

    v_cvt_pk_bf16_f32 v48, v74, v75
    v_lshlrev_b32 v49, 16, v48
    v_and_b32 v50, s23, v48
    v_add_f32 v49, v49, v18
    v_add_f32 v50, v50, v19
    v_cvt_pk_bf16_f32 v48, v49, v50
    v_lshlrev_b32 v18, 16, v48
    v_and_b32 v19, s23, v48

    v_cvt_pk_bf16_f32 v48, v76, v77
    v_lshlrev_b32 v49, 16, v48
    v_and_b32 v50, s23, v48
    v_add_f32 v49, v49, v20
    v_add_f32 v50, v50, v21
    v_cvt_pk_bf16_f32 v48, v49, v50
    v_lshlrev_b32 v20, 16, v48
    v_and_b32 v21, s23, v48

    v_cvt_pk_bf16_f32 v48, v78, v79
    v_lshlrev_b32 v49, 16, v48
    v_and_b32 v50, s23, v48
    v_add_f32 v49, v49, v22
    v_add_f32 v50, v50, v23
    v_cvt_pk_bf16_f32 v48, v49, v50
    v_lshlrev_b32 v22, 16, v48
    v_and_b32 v23, s23, v48

    v_add_f32 v80, v8, v9
    v_add_f32 v80, v80, v10
    v_add_f32 v80, v80, v11
    v_add_f32 v80, v80, v12
    v_add_f32 v80, v80, v13
    v_add_f32 v80, v80, v14
    v_add_f32 v80, v80, v15
    v_add_f32 v80, v80, v16
    v_add_f32 v80, v80, v17
    v_add_f32 v80, v80, v18
    v_add_f32 v80, v80, v19
    v_add_f32 v80, v80, v20
    v_add_f32 v80, v80, v21
    v_add_f32 v80, v80, v22
    v_add_f32 v80, v80, v23
    s_nop 1
    v_add_f32_dpp v81, v80, v80 quad_perm:[1,0,3,2] row_mask:0xf bank_mask:0xf
    v_mov_b32 v80, v81

    s_nop 1
    v_add_f32_dpp v81, v80, v80 quad_perm:[2,3,0,1] row_mask:0xf bank_mask:0xf
    v_mov_b32 v80, v81

    s_nop 1
    v_add_f32_dpp v81, v80, v80 row_half_mirror row_mask:0xf bank_mask:0xf
    v_mov_b32 v80, v81

    s_nop 1
    v_add_f32_dpp v81, v80, v80 row_mirror row_mask:0xf bank_mask:0xf
    v_mov_b32 v80, v81

    s_nop 1
    v_readlane_b32 s40, v80, 0
    v_readlane_b32 s41, v80, 16
    v_readlane_b32 s42, v80, 32
    v_readlane_b32 s43, v80, 48
    s_nop 3
    v_mov_b32 v80, s40
    v_add_f32 v80, s41, v80
    v_add_f32 v80, s42, v80
    v_add_f32 v80, s43, v80

    v_mul_f32 v80, s24, v80

    v_sub_f32 v64, v8, v80
    v_sub_f32 v65, v9, v80
    v_sub_f32 v66, v10, v80
    v_sub_f32 v67, v11, v80
    v_sub_f32 v68, v12, v80
    v_sub_f32 v69, v13, v80
    v_sub_f32 v70, v14, v80
    v_sub_f32 v71, v15, v80
    v_sub_f32 v72, v16, v80
    v_sub_f32 v73, v17, v80
    v_sub_f32 v74, v18, v80
    v_sub_f32 v75, v19, v80
    v_sub_f32 v76, v20, v80
    v_sub_f32 v77, v21, v80
    v_sub_f32 v78, v22, v80
    v_sub_f32 v79, v23, v80
    v_mul_f32 v72, v72, v30
    v_mul_f32 v73, v73, v30
    v_mul_f32 v74, v74, v30
    v_mul_f32 v75, v75, v30
    v_mul_f32 v76, v76, v30
    v_mul_f32 v77, v77, v30
    v_mul_f32 v78, v78, v30
    v_mul_f32 v79, v79, v30
    v_mul_f32 v82, v64, v64
    v_fmac_f32 v82, v65, v65
    v_fmac_f32 v82, v66, v66
    v_fmac_f32 v82, v67, v67
    v_fmac_f32 v82, v68, v68
    v_fmac_f32 v82, v69, v69
    v_fmac_f32 v82, v70, v70
    v_fmac_f32 v82, v71, v71
    v_fmac_f32 v82, v72, v72
    v_fmac_f32 v82, v73, v73
    v_fmac_f32 v82, v74, v74
    v_fmac_f32 v82, v75, v75
    v_fmac_f32 v82, v76, v76
    v_fmac_f32 v82, v77, v77
    v_fmac_f32 v82, v78, v78
    v_fmac_f32 v82, v79, v79
    s_nop 1
    v_add_f32_dpp v83, v82, v82 quad_perm:[1,0,3,2] row_mask:0xf bank_mask:0xf
    v_mov_b32 v82, v83

    s_nop 1
    v_add_f32_dpp v83, v82, v82 quad_perm:[2,3,0,1] row_mask:0xf bank_mask:0xf
    v_mov_b32 v82, v83

    s_nop 1
    v_add_f32_dpp v83, v82, v82 row_half_mirror row_mask:0xf bank_mask:0xf
    v_mov_b32 v82, v83

    s_nop 1
    v_add_f32_dpp v83, v82, v82 row_mirror row_mask:0xf bank_mask:0xf
    v_mov_b32 v82, v83

    s_nop 1
    v_readlane_b32 s40, v82, 0
    v_readlane_b32 s41, v82, 16
    v_readlane_b32 s42, v82, 32
    v_readlane_b32 s43, v82, 48
    s_nop 3
    v_mov_b32 v82, s40
    v_add_f32 v82, s41, v82
    v_add_f32 v82, s42, v82
    v_add_f32 v82, s43, v82

    v_mul_f32 v82, s24, v82
    v_cvt_pk_bf16_f32 v83, v80, v82
    v_lshlrev_b32 v80, 16, v83
    v_and_b32 v82, s23, v83
    v_add_f32 v82, s25, v82
    v_cvt_pk_bf16_f32 v82, v82, v82
    v_lshlrev_b32 v82, 16, v82
    v_sqrt_f32 v82, v82
    s_nop 0
    v_cvt_pk_bf16_f32 v82, v82, v82
    v_lshlrev_b32 v82, 16, v82
    v_rcp_f32 v84, v82
    s_nop 0

    v_sub_f32 v64, v8, v80
    v_sub_f32 v65, v9, v80
    v_cvt_pk_bf16_f32 v85, v64, v65
    v_lshlrev_b32 v64, 16, v85
    v_and_b32 v65, s23, v85
    v_mul_f32 v86, v64, v84
    v_mul_f32 v87, v65, v84
    v_fma_f32 v64, -v86, v82, v64
    v_fma_f32 v65, -v87, v82, v65
    v_fmac_f32 v86, v64, v84
    v_fmac_f32 v87, v65, v84
    v_cvt_pk_bf16_f32 v85, v86, v87
    v_lshlrev_b32 v64, 16, v85
    v_and_b32 v65, s23, v85

    v_sub_f32 v66, v10, v80
    v_sub_f32 v67, v11, v80
    v_cvt_pk_bf16_f32 v85, v66, v67
    v_lshlrev_b32 v66, 16, v85
    v_and_b32 v67, s23, v85
    v_mul_f32 v86, v66, v84
    v_mul_f32 v87, v67, v84
    v_fma_f32 v66, -v86, v82, v66
    v_fma_f32 v67, -v87, v82, v67
    v_fmac_f32 v86, v66, v84
    v_fmac_f32 v87, v67, v84
    v_cvt_pk_bf16_f32 v85, v86, v87
    v_lshlrev_b32 v66, 16, v85
    v_and_b32 v67, s23, v85

    v_sub_f32 v68, v12, v80
    v_sub_f32 v69, v13, v80
    v_cvt_pk_bf16_f32 v85, v68, v69
    v_lshlrev_b32 v68, 16, v85
    v_and_b32 v69, s23, v85
    v_mul_f32 v86, v68, v84
    v_mul_f32 v87, v69, v84
    v_fma_f32 v68, -v86, v82, v68
    v_fma_f32 v69, -v87, v82, v69
    v_fmac_f32 v86, v68, v84
    v_fmac_f32 v87, v69, v84
    v_cvt_pk_bf16_f32 v85, v86, v87
    v_lshlrev_b32 v68, 16, v85
    v_and_b32 v69, s23, v85

    v_sub_f32 v70, v14, v80
    v_sub_f32 v71, v15, v80
    v_cvt_pk_bf16_f32 v85, v70, v71
    v_lshlrev_b32 v70, 16, v85
    v_and_b32 v71, s23, v85
    v_mul_f32 v86, v70, v84
    v_mul_f32 v87, v71, v84
    v_fma_f32 v70, -v86, v82, v70
    v_fma_f32 v71, -v87, v82, v71
    v_fmac_f32 v86, v70, v84
    v_fmac_f32 v87, v71, v84
    v_cvt_pk_bf16_f32 v85, v86, v87
    v_lshlrev_b32 v70, 16, v85
    v_and_b32 v71, s23, v85

    v_sub_f32 v72, v16, v80
    v_sub_f32 v73, v17, v80
    v_cvt_pk_bf16_f32 v85, v72, v73
    v_lshlrev_b32 v72, 16, v85
    v_and_b32 v73, s23, v85
    v_mul_f32 v86, v72, v84
    v_mul_f32 v87, v73, v84
    v_fma_f32 v72, -v86, v82, v72
    v_fma_f32 v73, -v87, v82, v73
    v_fmac_f32 v86, v72, v84
    v_fmac_f32 v87, v73, v84
    v_cvt_pk_bf16_f32 v85, v86, v87
    v_lshlrev_b32 v72, 16, v85
    v_and_b32 v73, s23, v85

    v_sub_f32 v74, v18, v80
    v_sub_f32 v75, v19, v80
    v_cvt_pk_bf16_f32 v85, v74, v75
    v_lshlrev_b32 v74, 16, v85
    v_and_b32 v75, s23, v85
    v_mul_f32 v86, v74, v84
    v_mul_f32 v87, v75, v84
    v_fma_f32 v74, -v86, v82, v74
    v_fma_f32 v75, -v87, v82, v75
    v_fmac_f32 v86, v74, v84
    v_fmac_f32 v87, v75, v84
    v_cvt_pk_bf16_f32 v85, v86, v87
    v_lshlrev_b32 v74, 16, v85
    v_and_b32 v75, s23, v85

    v_sub_f32 v76, v20, v80
    v_sub_f32 v77, v21, v80
    v_cvt_pk_bf16_f32 v85, v76, v77
    v_lshlrev_b32 v76, 16, v85
    v_and_b32 v77, s23, v85
    v_mul_f32 v86, v76, v84
    v_mul_f32 v87, v77, v84
    v_fma_f32 v76, -v86, v82, v76
    v_fma_f32 v77, -v87, v82, v77
    v_fmac_f32 v86, v76, v84
    v_fmac_f32 v87, v77, v84
    v_cvt_pk_bf16_f32 v85, v86, v87
    v_lshlrev_b32 v76, 16, v85
    v_and_b32 v77, s23, v85

    v_sub_f32 v78, v22, v80
    v_sub_f32 v79, v23, v80
    v_cvt_pk_bf16_f32 v85, v78, v79
    v_lshlrev_b32 v78, 16, v85
    v_and_b32 v79, s23, v85
    v_mul_f32 v86, v78, v84
    v_mul_f32 v87, v79, v84
    v_fma_f32 v78, -v86, v82, v78
    v_fma_f32 v79, -v87, v82, v79
    v_fmac_f32 v86, v78, v84
    v_fmac_f32 v87, v79, v84
    v_cvt_pk_bf16_f32 v85, v86, v87
    v_lshlrev_b32 v78, 16, v85
    v_and_b32 v79, s23, v85

    s_waitcnt lgkmcnt(0)
    v_lshlrev_b32 v96, 16, v128
    v_and_b32 v97, s23, v128

    v_lshlrev_b32 v98, 16, v129
    v_and_b32 v99, s23, v129

    v_lshlrev_b32 v100, 16, v130
    v_and_b32 v101, s23, v130

    v_lshlrev_b32 v102, 16, v131
    v_and_b32 v103, s23, v131

    v_lshlrev_b32 v104, 16, v132
    v_and_b32 v105, s23, v132

    v_lshlrev_b32 v106, 16, v133
    v_and_b32 v107, s23, v133

    v_lshlrev_b32 v108, 16, v134
    v_and_b32 v109, s23, v134

    v_lshlrev_b32 v110, 16, v135
    v_and_b32 v111, s23, v135

    v_mul_f32 v49, v64, v96
    v_mul_f32 v50, v65, v97
    v_cvt_pk_bf16_f32 v48, v49, v50
    v_lshlrev_b32 v49, 16, v48
    v_and_b32 v50, s23, v48
    v_add_f32 v49, v49, v8
    v_add_f32 v50, v50, v9
    v_cvt_pk_bf16_f32 v48, v49, v50
    v_lshlrev_b32 v8, 16, v48
    v_and_b32 v9, s23, v48

    v_mul_f32 v49, v66, v98
    v_mul_f32 v50, v67, v99
    v_cvt_pk_bf16_f32 v48, v49, v50
    v_lshlrev_b32 v49, 16, v48
    v_and_b32 v50, s23, v48
    v_add_f32 v49, v49, v10
    v_add_f32 v50, v50, v11
    v_cvt_pk_bf16_f32 v48, v49, v50
    v_lshlrev_b32 v10, 16, v48
    v_and_b32 v11, s23, v48

    v_mul_f32 v49, v68, v100
    v_mul_f32 v50, v69, v101
    v_cvt_pk_bf16_f32 v48, v49, v50
    v_lshlrev_b32 v49, 16, v48
    v_and_b32 v50, s23, v48
    v_add_f32 v49, v49, v12
    v_add_f32 v50, v50, v13
    v_cvt_pk_bf16_f32 v48, v49, v50
    v_lshlrev_b32 v12, 16, v48
    v_and_b32 v13, s23, v48

    v_mul_f32 v49, v70, v102
    v_mul_f32 v50, v71, v103
    v_cvt_pk_bf16_f32 v48, v49, v50
    v_lshlrev_b32 v49, 16, v48
    v_and_b32 v50, s23, v48
    v_add_f32 v49, v49, v14
    v_add_f32 v50, v50, v15
    v_cvt_pk_bf16_f32 v48, v49, v50
    v_lshlrev_b32 v14, 16, v48
    v_and_b32 v15, s23, v48

    v_mul_f32 v49, v72, v104
    v_mul_f32 v50, v73, v105
    v_cvt_pk_bf16_f32 v48, v49, v50
    v_lshlrev_b32 v49, 16, v48
    v_and_b32 v50, s23, v48
    v_add_f32 v49, v49, v16
    v_add_f32 v50, v50, v17
    v_cvt_pk_bf16_f32 v48, v49, v50
    v_lshlrev_b32 v16, 16, v48
    v_and_b32 v17, s23, v48

    v_mul_f32 v49, v74, v106
    v_mul_f32 v50, v75, v107
    v_cvt_pk_bf16_f32 v48, v49, v50
    v_lshlrev_b32 v49, 16, v48
    v_and_b32 v50, s23, v48
    v_add_f32 v49, v49, v18
    v_add_f32 v50, v50, v19
    v_cvt_pk_bf16_f32 v48, v49, v50
    v_lshlrev_b32 v18, 16, v48
    v_and_b32 v19, s23, v48

    v_mul_f32 v49, v76, v108
    v_mul_f32 v50, v77, v109
    v_cvt_pk_bf16_f32 v48, v49, v50
    v_lshlrev_b32 v49, 16, v48
    v_and_b32 v50, s23, v48
    v_add_f32 v49, v49, v20
    v_add_f32 v50, v50, v21
    v_cvt_pk_bf16_f32 v48, v49, v50
    v_lshlrev_b32 v20, 16, v48
    v_and_b32 v21, s23, v48

    v_mul_f32 v49, v78, v110
    v_mul_f32 v50, v79, v111
    v_cvt_pk_bf16_f32 v48, v49, v50
    v_lshlrev_b32 v49, 16, v48
    v_and_b32 v50, s23, v48
    v_add_f32 v49, v49, v22
    v_add_f32 v50, v50, v23
    v_cvt_pk_bf16_f32 v48, v49, v50
    v_lshlrev_b32 v22, 16, v48
    v_and_b32 v23, s23, v48

    v_cvt_pk_bf16_f32 v48, v8, v9
    v_cvt_pk_bf16_f32 v49, v10, v11
    v_cvt_pk_bf16_f32 v50, v12, v13
    v_cvt_pk_bf16_f32 v51, v14, v15
    v_cvt_pk_bf16_f32 v52, v16, v17
    v_cvt_pk_bf16_f32 v53, v18, v19
    v_cvt_pk_bf16_f32 v54, v20, v21
    v_cvt_pk_bf16_f32 v55, v22, v23
    buffer_store_dwordx4 v[48:51], v3, s[32:35], 0 offen
    s_mov_b64 exec, s[26:27]
    buffer_store_dwordx4 v[52:55], v4, s[32:35], 0 offen
    s_mov_b64 exec, -1

    v_add_f32 v80, v8, v9
    v_add_f32 v80, v80, v10
    v_add_f32 v80, v80, v11
    v_add_f32 v80, v80, v12
    v_add_f32 v80, v80, v13
    v_add_f32 v80, v80, v14
    v_add_f32 v80, v80, v15
    v_add_f32 v80, v80, v16
    v_add_f32 v80, v80, v17
    v_add_f32 v80, v80, v18
    v_add_f32 v80, v80, v19
    v_add_f32 v80, v80, v20
    v_add_f32 v80, v80, v21
    v_add_f32 v80, v80, v22
    v_add_f32 v80, v80, v23
    s_nop 1
    v_add_f32_dpp v81, v80, v80 quad_perm:[1,0,3,2] row_mask:0xf bank_mask:0xf
    v_mov_b32 v80, v81

    s_nop 1
    v_add_f32_dpp v81, v80, v80 quad_perm:[2,3,0,1] row_mask:0xf bank_mask:0xf
    v_mov_b32 v80, v81

    s_nop 1
    v_add_f32_dpp v81, v80, v80 row_half_mirror row_mask:0xf bank_mask:0xf
    v_mov_b32 v80, v81

    s_nop 1
    v_add_f32_dpp v81, v80, v80 row_mirror row_mask:0xf bank_mask:0xf
    v_mov_b32 v80, v81

    s_nop 1
    v_readlane_b32 s40, v80, 0
    v_readlane_b32 s41, v80, 16
    v_readlane_b32 s42, v80, 32
    v_readlane_b32 s43, v80, 48
    s_nop 3
    v_mov_b32 v80, s40
    v_add_f32 v80, s41, v80
    v_add_f32 v80, s42, v80
    v_add_f32 v80, s43, v80

    v_mul_f32 v80, s24, v80

    v_sub_f32 v64, v8, v80
    v_sub_f32 v65, v9, v80
    v_sub_f32 v66, v10, v80
    v_sub_f32 v67, v11, v80
    v_sub_f32 v68, v12, v80
    v_sub_f32 v69, v13, v80
    v_sub_f32 v70, v14, v80
    v_sub_f32 v71, v15, v80
    v_sub_f32 v72, v16, v80
    v_sub_f32 v73, v17, v80
    v_sub_f32 v74, v18, v80
    v_sub_f32 v75, v19, v80
    v_sub_f32 v76, v20, v80
    v_sub_f32 v77, v21, v80
    v_sub_f32 v78, v22, v80
    v_sub_f32 v79, v23, v80
    v_mul_f32 v72, v72, v30
    v_mul_f32 v73, v73, v30
    v_mul_f32 v74, v74, v30
    v_mul_f32 v75, v75, v30
    v_mul_f32 v76, v76, v30
    v_mul_f32 v77, v77, v30
    v_mul_f32 v78, v78, v30
    v_mul_f32 v79, v79, v30
    v_mul_f32 v82, v64, v64
    v_fmac_f32 v82, v65, v65
    v_fmac_f32 v82, v66, v66
    v_fmac_f32 v82, v67, v67
    v_fmac_f32 v82, v68, v68
    v_fmac_f32 v82, v69, v69
    v_fmac_f32 v82, v70, v70
    v_fmac_f32 v82, v71, v71
    v_fmac_f32 v82, v72, v72
    v_fmac_f32 v82, v73, v73
    v_fmac_f32 v82, v74, v74
    v_fmac_f32 v82, v75, v75
    v_fmac_f32 v82, v76, v76
    v_fmac_f32 v82, v77, v77
    v_fmac_f32 v82, v78, v78
    v_fmac_f32 v82, v79, v79
    s_nop 1
    v_add_f32_dpp v83, v82, v82 quad_perm:[1,0,3,2] row_mask:0xf bank_mask:0xf
    v_mov_b32 v82, v83

    s_nop 1
    v_add_f32_dpp v83, v82, v82 quad_perm:[2,3,0,1] row_mask:0xf bank_mask:0xf
    v_mov_b32 v82, v83

    s_nop 1
    v_add_f32_dpp v83, v82, v82 row_half_mirror row_mask:0xf bank_mask:0xf
    v_mov_b32 v82, v83

    s_nop 1
    v_add_f32_dpp v83, v82, v82 row_mirror row_mask:0xf bank_mask:0xf
    v_mov_b32 v82, v83

    s_nop 1
    v_readlane_b32 s40, v82, 0
    v_readlane_b32 s41, v82, 16
    v_readlane_b32 s42, v82, 32
    v_readlane_b32 s43, v82, 48
    s_nop 3
    v_mov_b32 v82, s40
    v_add_f32 v82, s41, v82
    v_add_f32 v82, s42, v82
    v_add_f32 v82, s43, v82

    v_mul_f32 v82, s24, v82
    v_cvt_pk_bf16_f32 v83, v80, v82
    v_lshlrev_b32 v80, 16, v83
    v_and_b32 v82, s23, v83
    v_add_f32 v82, s25, v82
    v_cvt_pk_bf16_f32 v82, v82, v82
    v_lshlrev_b32 v82, 16, v82
    v_sqrt_f32 v82, v82
    s_nop 0
    v_cvt_pk_bf16_f32 v82, v82, v82
    v_lshlrev_b32 v82, 16, v82
    v_rcp_f32 v84, v82
    s_nop 0

    v_sub_f32 v64, v8, v80
    v_sub_f32 v65, v9, v80
    v_cvt_pk_bf16_f32 v85, v64, v65
    v_lshlrev_b32 v64, 16, v85
    v_and_b32 v65, s23, v85
    v_mul_f32 v86, v64, v84
    v_mul_f32 v87, v65, v84
    v_fma_f32 v64, -v86, v82, v64
    v_fma_f32 v65, -v87, v82, v65
    v_fmac_f32 v86, v64, v84
    v_fmac_f32 v87, v65, v84
    v_cvt_pk_bf16_f32 v85, v86, v87
    v_lshlrev_b32 v64, 16, v85
    v_and_b32 v65, s23, v85

    v_sub_f32 v66, v10, v80
    v_sub_f32 v67, v11, v80
    v_cvt_pk_bf16_f32 v85, v66, v67
    v_lshlrev_b32 v66, 16, v85
    v_and_b32 v67, s23, v85
    v_mul_f32 v86, v66, v84
    v_mul_f32 v87, v67, v84
    v_fma_f32 v66, -v86, v82, v66
    v_fma_f32 v67, -v87, v82, v67
    v_fmac_f32 v86, v66, v84
    v_fmac_f32 v87, v67, v84
    v_cvt_pk_bf16_f32 v85, v86, v87
    v_lshlrev_b32 v66, 16, v85
    v_and_b32 v67, s23, v85

    v_sub_f32 v68, v12, v80
    v_sub_f32 v69, v13, v80
    v_cvt_pk_bf16_f32 v85, v68, v69
    v_lshlrev_b32 v68, 16, v85
    v_and_b32 v69, s23, v85
    v_mul_f32 v86, v68, v84
    v_mul_f32 v87, v69, v84
    v_fma_f32 v68, -v86, v82, v68
    v_fma_f32 v69, -v87, v82, v69
    v_fmac_f32 v86, v68, v84
    v_fmac_f32 v87, v69, v84
    v_cvt_pk_bf16_f32 v85, v86, v87
    v_lshlrev_b32 v68, 16, v85
    v_and_b32 v69, s23, v85

    v_sub_f32 v70, v14, v80
    v_sub_f32 v71, v15, v80
    v_cvt_pk_bf16_f32 v85, v70, v71
    v_lshlrev_b32 v70, 16, v85
    v_and_b32 v71, s23, v85
    v_mul_f32 v86, v70, v84
    v_mul_f32 v87, v71, v84
    v_fma_f32 v70, -v86, v82, v70
    v_fma_f32 v71, -v87, v82, v71
    v_fmac_f32 v86, v70, v84
    v_fmac_f32 v87, v71, v84
    v_cvt_pk_bf16_f32 v85, v86, v87
    v_lshlrev_b32 v70, 16, v85
    v_and_b32 v71, s23, v85

    v_sub_f32 v72, v16, v80
    v_sub_f32 v73, v17, v80
    v_cvt_pk_bf16_f32 v85, v72, v73
    v_lshlrev_b32 v72, 16, v85
    v_and_b32 v73, s23, v85
    v_mul_f32 v86, v72, v84
    v_mul_f32 v87, v73, v84
    v_fma_f32 v72, -v86, v82, v72
    v_fma_f32 v73, -v87, v82, v73
    v_fmac_f32 v86, v72, v84
    v_fmac_f32 v87, v73, v84
    v_cvt_pk_bf16_f32 v85, v86, v87
    v_lshlrev_b32 v72, 16, v85
    v_and_b32 v73, s23, v85

    v_sub_f32 v74, v18, v80
    v_sub_f32 v75, v19, v80
    v_cvt_pk_bf16_f32 v85, v74, v75
    v_lshlrev_b32 v74, 16, v85
    v_and_b32 v75, s23, v85
    v_mul_f32 v86, v74, v84
    v_mul_f32 v87, v75, v84
    v_fma_f32 v74, -v86, v82, v74
    v_fma_f32 v75, -v87, v82, v75
    v_fmac_f32 v86, v74, v84
    v_fmac_f32 v87, v75, v84
    v_cvt_pk_bf16_f32 v85, v86, v87
    v_lshlrev_b32 v74, 16, v85
    v_and_b32 v75, s23, v85

    v_sub_f32 v76, v20, v80
    v_sub_f32 v77, v21, v80
    v_cvt_pk_bf16_f32 v85, v76, v77
    v_lshlrev_b32 v76, 16, v85
    v_and_b32 v77, s23, v85
    v_mul_f32 v86, v76, v84
    v_mul_f32 v87, v77, v84
    v_fma_f32 v76, -v86, v82, v76
    v_fma_f32 v77, -v87, v82, v77
    v_fmac_f32 v86, v76, v84
    v_fmac_f32 v87, v77, v84
    v_cvt_pk_bf16_f32 v85, v86, v87
    v_lshlrev_b32 v76, 16, v85
    v_and_b32 v77, s23, v85

    v_sub_f32 v78, v22, v80
    v_sub_f32 v79, v23, v80
    v_cvt_pk_bf16_f32 v85, v78, v79
    v_lshlrev_b32 v78, 16, v85
    v_and_b32 v79, s23, v85
    v_mul_f32 v86, v78, v84
    v_mul_f32 v87, v79, v84
    v_fma_f32 v78, -v86, v82, v78
    v_fma_f32 v79, -v87, v82, v79
    v_fmac_f32 v86, v78, v84
    v_fmac_f32 v87, v79, v84
    v_cvt_pk_bf16_f32 v85, v86, v87
    v_lshlrev_b32 v78, 16, v85
    v_and_b32 v79, s23, v85

    v_cvt_pk_bf16_f32 v48, v64, v65
    v_cvt_pk_bf16_f32 v49, v66, v67
    v_cvt_pk_bf16_f32 v50, v68, v69
    v_cvt_pk_bf16_f32 v51, v70, v71
    v_cvt_pk_bf16_f32 v52, v72, v73
    v_cvt_pk_bf16_f32 v53, v74, v75
    v_cvt_pk_bf16_f32 v54, v76, v77
    v_cvt_pk_bf16_f32 v55, v78, v79
    buffer_store_dwordx4 v[48:51], v3, s[36:39], 0 offen
    s_mov_b64 exec, s[26:27]
    buffer_store_dwordx4 v[52:55], v4, s[36:39], 0 offen
    s_mov_b64 exec, -1

row1_done:
    s_endpgm
.globl row2_kernel
.p2align 8
.type row2_kernel,@function
row2_kernel:
    s_cmp_ge_u32 s2, 256
    s_cbranch_scc1 row2_done
    s_load_dwordx2 s[4:5], s[0:1], 0
    s_load_dwordx2 s[6:7], s[0:1], 96
    s_load_dwordx2 s[8:9], s[0:1], 80
    s_mov_b32 s23, 0xffff0000
    s_mov_b32 s24, 0x3ae38e39
    s_mov_b32 s25, 0x3727c5ac
    s_mov_b64 s[26:27], 0xff
    v_lshrrev_b32 v7, 6, v0
    v_and_b32 v2, 63, v0
    s_lshl_b32 s3, s2, 3
    v_add_u32 v1, s3, v7
    v_mul_u32_u24 v3, 1152, v1
    v_lshlrev_b32 v4, 4, v2
    v_add_u32 v3, v3, v4
    v_add_u32 v4, 1024, v3
    v_cmp_gt_u32 vcc, 8, v2
    v_mov_b32 v30, 0
    v_mov_b32 v31, 1.0
    s_nop 1
    v_cndmask_b32 v30, v30, v31, vcc
    s_waitcnt lgkmcnt(0)

    s_add_u32 s12, s6, 12582912
    s_addc_u32 s13, s7, 0
    s_mov_b32 s14, 2359296
    s_mov_b32 s15, 0x00020000
    s_mov_b32 s16, s6
    s_mov_b32 s17, s7
    s_mov_b32 s18, 2359296
    s_mov_b32 s19, 0x00020000
    s_add_u32 s28, s6, 50331648
    s_addc_u32 s29, s7, 0
    s_mov_b32 s30, 18874368
    s_mov_b32 s31, 0x00020000
    s_mov_b32 s32, s8
    s_mov_b32 s33, s9
    s_mov_b32 s34, 2359296
    s_mov_b32 s35, 0x00020000
    s_add_u32 s36, s6, 8388608
    s_addc_u32 s37, s7, 0
    s_mov_b32 s38, 2359296
    s_mov_b32 s39, 0x00020000
    v_mov_b32 v36, 0
    v_mov_b32 v37, 0
    v_mov_b32 v38, 0
    v_mov_b32 v39, 0
    v_mov_b32 v44, 0
    v_mov_b32 v45, 0
    v_mov_b32 v46, 0
    v_mov_b32 v47, 0
    buffer_load_dwordx4 v[32:35], v3, s[12:15], 0 offen

    s_mov_b64 exec, s[26:27]
    buffer_load_dwordx4 v[36:39], v4, s[12:15], 0 offen
    s_mov_b64 exec, -1
    v_lshlrev_b32 v5, 1, v3
    v_add_u32 v6, 2048, v5

    v_mov_b32 v64, 0
    v_mov_b32 v65, 0
    v_mov_b32 v66, 0
    v_mov_b32 v67, 0
    v_mov_b32 v68, 0
    v_mov_b32 v69, 0
    v_mov_b32 v70, 0
    v_mov_b32 v71, 0
    v_mov_b32 v72, 0
    v_mov_b32 v73, 0
    v_mov_b32 v74, 0
    v_mov_b32 v75, 0
    v_mov_b32 v76, 0
    v_mov_b32 v77, 0
    v_mov_b32 v78, 0
    v_mov_b32 v79, 0
    v_mov_b32 v80, 0
    v_mov_b32 v81, 0
    v_mov_b32 v82, 0
    v_mov_b32 v83, 0
    v_mov_b32 v84, 0
    v_mov_b32 v85, 0
    v_mov_b32 v86, 0
    v_mov_b32 v87, 0
    v_mov_b32 v88, 0
    v_mov_b32 v89, 0
    v_mov_b32 v90, 0
    v_mov_b32 v91, 0
    v_mov_b32 v92, 0
    v_mov_b32 v93, 0
    v_mov_b32 v94, 0
    v_mov_b32 v95, 0
    v_mov_b32 v96, 0
    v_mov_b32 v97, 0
    v_mov_b32 v98, 0
    v_mov_b32 v99, 0
    v_mov_b32 v100, 0
    v_mov_b32 v101, 0
    v_mov_b32 v102, 0
    v_mov_b32 v103, 0
    v_mov_b32 v104, 0
    v_mov_b32 v105, 0
    v_mov_b32 v106, 0
    v_mov_b32 v107, 0
    v_mov_b32 v108, 0
    v_mov_b32 v109, 0
    v_mov_b32 v110, 0
    v_mov_b32 v111, 0
    v_mov_b32 v112, 0
    v_mov_b32 v113, 0
    v_mov_b32 v114, 0
    v_mov_b32 v115, 0
    v_mov_b32 v116, 0
    v_mov_b32 v117, 0
    v_mov_b32 v118, 0
    v_mov_b32 v119, 0
    v_mov_b32 v120, 0
    v_mov_b32 v121, 0
    v_mov_b32 v122, 0
    v_mov_b32 v123, 0
    v_mov_b32 v124, 0
    v_mov_b32 v125, 0
    v_mov_b32 v126, 0
    v_mov_b32 v127, 0
    s_mov_b32 s3, 0
    buffer_load_dwordx4 v[64:67], v5, s[28:31], s3 offen
    buffer_load_dwordx4 v[68:71], v5, s[28:31], s3 offen offset:16

    s_mov_b32 s3, 4718592
    buffer_load_dwordx4 v[80:83], v5, s[28:31], s3 offen
    buffer_load_dwordx4 v[84:87], v5, s[28:31], s3 offen offset:16

    s_mov_b32 s3, 9437184
    buffer_load_dwordx4 v[96:99], v5, s[28:31], s3 offen
    buffer_load_dwordx4 v[100:103], v5, s[28:31], s3 offen offset:16

    s_mov_b32 s3, 14155776
    buffer_load_dwordx4 v[112:115], v5, s[28:31], s3 offen
    buffer_load_dwordx4 v[116:119], v5, s[28:31], s3 offen offset:16

    s_mov_b64 exec, s[26:27]
    s_mov_b32 s3, 0
    buffer_load_dwordx4 v[72:75], v6, s[28:31], s3 offen
    buffer_load_dwordx4 v[76:79], v6, s[28:31], s3 offen offset:16

    s_mov_b32 s3, 4718592
    buffer_load_dwordx4 v[88:91], v6, s[28:31], s3 offen
    buffer_load_dwordx4 v[92:95], v6, s[28:31], s3 offen offset:16

    s_mov_b32 s3, 9437184
    buffer_load_dwordx4 v[104:107], v6, s[28:31], s3 offen
    buffer_load_dwordx4 v[108:111], v6, s[28:31], s3 offen offset:16

    s_mov_b32 s3, 14155776
    buffer_load_dwordx4 v[120:123], v6, s[28:31], s3 offen
    buffer_load_dwordx4 v[124:127], v6, s[28:31], s3 offen offset:16

    s_mov_b64 exec, -1
    s_waitcnt vmcnt(0)
    v_lshlrev_b32 v8, 16, v32
    v_and_b32 v9, s23, v32

    v_lshlrev_b32 v10, 16, v33
    v_and_b32 v11, s23, v33

    v_lshlrev_b32 v12, 16, v34
    v_and_b32 v13, s23, v34

    v_lshlrev_b32 v14, 16, v35
    v_and_b32 v15, s23, v35

    v_lshlrev_b32 v16, 16, v36
    v_and_b32 v17, s23, v36

    v_lshlrev_b32 v18, 16, v37
    v_and_b32 v19, s23, v37

    v_lshlrev_b32 v20, 16, v38
    v_and_b32 v21, s23, v38

    v_lshlrev_b32 v22, 16, v39
    v_and_b32 v23, s23, v39

    v_add_f32 v64, v64, v80
    v_add_f32 v96, v96, v112
    v_add_f32 v64, v64, v96

    v_add_f32 v65, v65, v81
    v_add_f32 v97, v97, v113
    v_add_f32 v65, v65, v97

    v_add_f32 v66, v66, v82
    v_add_f32 v98, v98, v114
    v_add_f32 v66, v66, v98

    v_add_f32 v67, v67, v83
    v_add_f32 v99, v99, v115
    v_add_f32 v67, v67, v99

    v_add_f32 v68, v68, v84
    v_add_f32 v100, v100, v116
    v_add_f32 v68, v68, v100

    v_add_f32 v69, v69, v85
    v_add_f32 v101, v101, v117
    v_add_f32 v69, v69, v101

    v_add_f32 v70, v70, v86
    v_add_f32 v102, v102, v118
    v_add_f32 v70, v70, v102

    v_add_f32 v71, v71, v87
    v_add_f32 v103, v103, v119
    v_add_f32 v71, v71, v103

    v_add_f32 v72, v72, v88
    v_add_f32 v104, v104, v120
    v_add_f32 v72, v72, v104

    v_add_f32 v73, v73, v89
    v_add_f32 v105, v105, v121
    v_add_f32 v73, v73, v105

    v_add_f32 v74, v74, v90
    v_add_f32 v106, v106, v122
    v_add_f32 v74, v74, v106

    v_add_f32 v75, v75, v91
    v_add_f32 v107, v107, v123
    v_add_f32 v75, v75, v107

    v_add_f32 v76, v76, v92
    v_add_f32 v108, v108, v124
    v_add_f32 v76, v76, v108

    v_add_f32 v77, v77, v93
    v_add_f32 v109, v109, v125
    v_add_f32 v77, v77, v109

    v_add_f32 v78, v78, v94
    v_add_f32 v110, v110, v126
    v_add_f32 v78, v78, v110

    v_add_f32 v79, v79, v95
    v_add_f32 v111, v111, v127
    v_add_f32 v79, v79, v111

    v_cvt_pk_bf16_f32 v48, v64, v65
    v_lshlrev_b32 v49, 16, v48
    v_and_b32 v50, s23, v48
    v_add_f32 v49, v49, v8
    v_add_f32 v50, v50, v9
    v_cvt_pk_bf16_f32 v48, v49, v50
    v_lshlrev_b32 v8, 16, v48
    v_and_b32 v9, s23, v48

    v_cvt_pk_bf16_f32 v48, v66, v67
    v_lshlrev_b32 v49, 16, v48
    v_and_b32 v50, s23, v48
    v_add_f32 v49, v49, v10
    v_add_f32 v50, v50, v11
    v_cvt_pk_bf16_f32 v48, v49, v50
    v_lshlrev_b32 v10, 16, v48
    v_and_b32 v11, s23, v48

    v_cvt_pk_bf16_f32 v48, v68, v69
    v_lshlrev_b32 v49, 16, v48
    v_and_b32 v50, s23, v48
    v_add_f32 v49, v49, v12
    v_add_f32 v50, v50, v13
    v_cvt_pk_bf16_f32 v48, v49, v50
    v_lshlrev_b32 v12, 16, v48
    v_and_b32 v13, s23, v48

    v_cvt_pk_bf16_f32 v48, v70, v71
    v_lshlrev_b32 v49, 16, v48
    v_and_b32 v50, s23, v48
    v_add_f32 v49, v49, v14
    v_add_f32 v50, v50, v15
    v_cvt_pk_bf16_f32 v48, v49, v50
    v_lshlrev_b32 v14, 16, v48
    v_and_b32 v15, s23, v48

    v_cvt_pk_bf16_f32 v48, v72, v73
    v_lshlrev_b32 v49, 16, v48
    v_and_b32 v50, s23, v48
    v_add_f32 v49, v49, v16
    v_add_f32 v50, v50, v17
    v_cvt_pk_bf16_f32 v48, v49, v50
    v_lshlrev_b32 v16, 16, v48
    v_and_b32 v17, s23, v48

    v_cvt_pk_bf16_f32 v48, v74, v75
    v_lshlrev_b32 v49, 16, v48
    v_and_b32 v50, s23, v48
    v_add_f32 v49, v49, v18
    v_add_f32 v50, v50, v19
    v_cvt_pk_bf16_f32 v48, v49, v50
    v_lshlrev_b32 v18, 16, v48
    v_and_b32 v19, s23, v48

    v_cvt_pk_bf16_f32 v48, v76, v77
    v_lshlrev_b32 v49, 16, v48
    v_and_b32 v50, s23, v48
    v_add_f32 v49, v49, v20
    v_add_f32 v50, v50, v21
    v_cvt_pk_bf16_f32 v48, v49, v50
    v_lshlrev_b32 v20, 16, v48
    v_and_b32 v21, s23, v48

    v_cvt_pk_bf16_f32 v48, v78, v79
    v_lshlrev_b32 v49, 16, v48
    v_and_b32 v50, s23, v48
    v_add_f32 v49, v49, v22
    v_add_f32 v50, v50, v23
    v_cvt_pk_bf16_f32 v48, v49, v50
    v_lshlrev_b32 v22, 16, v48
    v_and_b32 v23, s23, v48

    v_cvt_pk_bf16_f32 v48, v8, v9
    v_cvt_pk_bf16_f32 v49, v10, v11
    v_cvt_pk_bf16_f32 v50, v12, v13
    v_cvt_pk_bf16_f32 v51, v14, v15
    v_cvt_pk_bf16_f32 v52, v16, v17
    v_cvt_pk_bf16_f32 v53, v18, v19
    v_cvt_pk_bf16_f32 v54, v20, v21
    v_cvt_pk_bf16_f32 v55, v22, v23
    buffer_store_dwordx4 v[48:51], v3, s[32:35], 0 offen
    s_mov_b64 exec, s[26:27]
    buffer_store_dwordx4 v[52:55], v4, s[32:35], 0 offen
    s_mov_b64 exec, -1

row2_done:
    s_endpgm
.globl gemm1_kernel
.p2align 8
.type gemm1_kernel,@function
gemm1_kernel:
    s_cmp_ge_u32 s2, 256
    s_cbranch_scc1 gemm1_done
    s_load_dwordx2 s[4:5], s[0:1], 96
    s_load_dwordx2 s[6:7], s[0:1], 56
    s_load_dwordx2 s[8:9], s[0:1], 64
    s_and_b32 s20, s2, 7
    s_lshr_b32 s21, s2, 3

    s_and_b32 s22, s21, 7
    s_lshr_b32 s23, s21, 3
    s_lshl_b32 s3, s20, 2
    s_add_u32 s23, s23, s3
    s_mov_b32 s24, 0

    v_lshrrev_b32 v1, 6, v0
    v_and_b32 v2, 63, v0
    s_nop 0
    v_readfirstlane_b32 s26, v1
    s_waitcnt lgkmcnt(0)

    s_add_u32 s10, s4, 8388608
    s_addc_u32 s11, s5, 0
    s_add_u32 s32, s4, 16777216
    s_addc_u32 s33, s5, 0
    s_mov_b32 s34, 18874368
    s_mov_b32 s35, 0x00020000
    s_mov_b32 s90, 2359296
    s_mov_b32 s91, 5308416
    s_mov_b32 s92, 294912
    s_add_u32 s27, s26, 0
    s_min_u32 s27, s27, 33
    s_and_b32 s3, s27, 15
    s_lshl_b32 s3, s3, 4
    v_lshrrev_b32 v44, 2, v2
    v_add_u32 v44, s3, v44
    v_lshrrev_b32 v45, 2, v44
    v_sub_u32 v45, 0, v45
    v_xor_b32 v45, v45, v2
    v_and_b32 v45, 3, v45
    v_lshlrev_b32 v45, 4, v45
    s_mul_i32 s3, s22, 256
    v_add_u32 v44, s3, v44
    s_mov_b32 s3, 1152
    v_mul_lo_u32 v44, v44, s3
    v_add_u32 v44, v44, v45
    s_lshr_b32 s3, s27, 3
    s_lshl_b32 s3, s3, 6
    s_mul_i32 s3, s3, 0
    v_add_u32 v44, s3, v44
    s_sub_u32 s28, s27, 16
    s_cmp_ge_i32 s28, 9
    s_cselect_b32 s29, 9, 0
    s_sub_u32 s28, s28, s29
    s_lshl_b32 s3, s28, 6
    v_add_u32 v45, s3, v2
    v_mul_u32_u24 v46, 3641, v45
    v_lshrrev_b32 v46, 16, v46
    v_mul_u32_u24 v47, 18, v46
    v_sub_u32 v47, v45, v47
    v_bfe_u32 v48, v46, 3, 1
    v_lshlrev_b32 v48, 2, v48
    v_xor_b32 v46, v46, v48
    s_mov_b32 s3, 9216
    v_mul_lo_u32 v46, v46, s3
    v_lshlrev_b32 v47, 4, v47
    v_add_u32 v46, v46, v47
    s_mul_i32 s3, s23, 288
    v_add_u32 v46, s3, v46
    s_cmp_ge_u32 s27, 25
    s_cselect_b32 s3, 0, 0
    v_add_u32 v46, s3, v46
    s_cselect_b32 s64, s8, s6
    s_cselect_b32 s65, s9, s7
    s_lshl_b32 s3, s24, 1
    s_mul_i32 s29, s24, 9216
    s_cmp_lt_u32 s27, 16
    s_cselect_b64 s[36:37], -1, 0
    s_cselect_b32 s64, s10, s64
    s_cselect_b32 s65, s11, s65
    s_cselect_b32 s66, s90, s91
    s_mov_b32 s67, 0x00020000
    s_cselect_b32 s76, s3, s29
    s_cselect_b32 s80, 64, s92
    s_lshl_b32 s84, s27, 10
    s_nop 1
    v_cndmask_b32 v3, v46, v44, s[36:37]

    s_add_u32 s27, s26, 12
    s_min_u32 s27, s27, 33
    s_and_b32 s3, s27, 15
    s_lshl_b32 s3, s3, 4
    v_lshrrev_b32 v44, 2, v2
    v_add_u32 v44, s3, v44
    v_lshrrev_b32 v45, 2, v44
    v_sub_u32 v45, 0, v45
    v_xor_b32 v45, v45, v2
    v_and_b32 v45, 3, v45
    v_lshlrev_b32 v45, 4, v45
    s_mul_i32 s3, s22, 256
    v_add_u32 v44, s3, v44
    s_mov_b32 s3, 1152
    v_mul_lo_u32 v44, v44, s3
    v_add_u32 v44, v44, v45
    s_lshr_b32 s3, s27, 3
    s_lshl_b32 s3, s3, 6
    s_mul_i32 s3, s3, 0
    v_add_u32 v44, s3, v44
    s_sub_u32 s28, s27, 16
    s_cmp_ge_i32 s28, 9
    s_cselect_b32 s29, 9, 0
    s_sub_u32 s28, s28, s29
    s_lshl_b32 s3, s28, 6
    v_add_u32 v45, s3, v2
    v_mul_u32_u24 v46, 3641, v45
    v_lshrrev_b32 v46, 16, v46
    v_mul_u32_u24 v47, 18, v46
    v_sub_u32 v47, v45, v47
    v_bfe_u32 v48, v46, 3, 1
    v_lshlrev_b32 v48, 2, v48
    v_xor_b32 v46, v46, v48
    s_mov_b32 s3, 9216
    v_mul_lo_u32 v46, v46, s3
    v_lshlrev_b32 v47, 4, v47
    v_add_u32 v46, v46, v47
    s_mul_i32 s3, s23, 288
    v_add_u32 v46, s3, v46
    s_cmp_ge_u32 s27, 25
    s_cselect_b32 s3, 0, 0
    v_add_u32 v46, s3, v46
    s_cselect_b32 s68, s8, s6
    s_cselect_b32 s69, s9, s7
    s_lshl_b32 s3, s24, 1
    s_mul_i32 s29, s24, 9216
    s_cmp_lt_u32 s27, 16
    s_cselect_b64 s[36:37], -1, 0
    s_cselect_b32 s68, s10, s68
    s_cselect_b32 s69, s11, s69
    s_cselect_b32 s70, s90, s91
    s_mov_b32 s71, 0x00020000
    s_cselect_b32 s77, s3, s29
    s_cselect_b32 s81, 64, s92
    s_lshl_b32 s85, s27, 10
    s_nop 1
    v_cndmask_b32 v4, v46, v44, s[36:37]

    s_add_u32 s27, s26, 24
    s_min_u32 s27, s27, 33
    s_and_b32 s3, s27, 15
    s_lshl_b32 s3, s3, 4
    v_lshrrev_b32 v44, 2, v2
    v_add_u32 v44, s3, v44
    v_lshrrev_b32 v45, 2, v44
    v_sub_u32 v45, 0, v45
    v_xor_b32 v45, v45, v2
    v_and_b32 v45, 3, v45
    v_lshlrev_b32 v45, 4, v45
    s_mul_i32 s3, s22, 256
    v_add_u32 v44, s3, v44
    s_mov_b32 s3, 1152
    v_mul_lo_u32 v44, v44, s3
    v_add_u32 v44, v44, v45
    s_lshr_b32 s3, s27, 3
    s_lshl_b32 s3, s3, 6
    s_mul_i32 s3, s3, 0
    v_add_u32 v44, s3, v44
    s_sub_u32 s28, s27, 16
    s_cmp_ge_i32 s28, 9
    s_cselect_b32 s29, 9, 0
    s_sub_u32 s28, s28, s29
    s_lshl_b32 s3, s28, 6
    v_add_u32 v45, s3, v2
    v_mul_u32_u24 v46, 3641, v45
    v_lshrrev_b32 v46, 16, v46
    v_mul_u32_u24 v47, 18, v46
    v_sub_u32 v47, v45, v47
    v_bfe_u32 v48, v46, 3, 1
    v_lshlrev_b32 v48, 2, v48
    v_xor_b32 v46, v46, v48
    s_mov_b32 s3, 9216
    v_mul_lo_u32 v46, v46, s3
    v_lshlrev_b32 v47, 4, v47
    v_add_u32 v46, v46, v47
    s_mul_i32 s3, s23, 288
    v_add_u32 v46, s3, v46
    s_cmp_ge_u32 s27, 25
    s_cselect_b32 s3, 0, 0
    v_add_u32 v46, s3, v46
    s_cselect_b32 s72, s8, s6
    s_cselect_b32 s73, s9, s7
    s_lshl_b32 s3, s24, 1
    s_mul_i32 s29, s24, 9216
    s_cmp_lt_u32 s27, 16
    s_cselect_b64 s[36:37], -1, 0
    s_cselect_b32 s72, s10, s72
    s_cselect_b32 s73, s11, s73
    s_cselect_b32 s74, s90, s91
    s_mov_b32 s75, 0x00020000
    s_cselect_b32 s78, s3, s29
    s_cselect_b32 s82, 64, s92
    s_lshl_b32 s86, s27, 10
    s_nop 1
    v_cndmask_b32 v5, v46, v44, s[36:37]

    s_add_u32 m0, s84, 0
    s_nop 0
    buffer_load_dwordx4 v3, s[64:67], s76 offen lds
    s_add_u32 s76, s76, s80

    s_add_u32 m0, s85, 0
    s_nop 0
    buffer_load_dwordx4 v4, s[68:71], s77 offen lds
    s_add_u32 s77, s77, s81

    s_add_u32 m0, s86, 0
    s_nop 0
    buffer_load_dwordx4 v5, s[72:75], s78 offen lds
    s_add_u32 s78, s78, s82

    s_add_u32 m0, s84, 34816
    s_nop 0
    buffer_load_dwordx4 v3, s[64:67], s76 offen lds
    s_add_u32 s76, s76, s80

    s_add_u32 m0, s85, 34816
    s_nop 0
    buffer_load_dwordx4 v4, s[68:71], s77 offen lds
    s_add_u32 s77, s77, s81

    s_add_u32 m0, s86, 34816
    s_nop 0
    buffer_load_dwordx4 v5, s[72:75], s78 offen lds
    s_add_u32 s78, s78, s82

    s_add_u32 m0, s84, 69632
    s_nop 0
    buffer_load_dwordx4 v3, s[64:67], s76 offen lds
    s_add_u32 s76, s76, s80

    s_add_u32 m0, s85, 69632
    s_nop 0
    buffer_load_dwordx4 v4, s[68:71], s77 offen lds
    s_add_u32 s77, s77, s81

    s_add_u32 m0, s86, 69632
    s_nop 0
    buffer_load_dwordx4 v5, s[72:75], s78 offen lds
    s_add_u32 s78, s78, s82

    s_cmp_ge_u32 s26, 12
    s_cselect_b32 s39, 1, 0
    s_mul_i32 s3, s39, 6
    s_sub_u32 s93, s26, s3
    s_cmp_ge_u32 s93, 4
    s_cselect_b32 s28, 1, 0
    s_cmp_ge_u32 s93, 8
    s_cselect_b32 s28, 2, s28
    s_mul_i32 s3, s28, 4
    s_sub_u32 s27, s93, s3
    v_and_b32 v44, 15, v2
    v_lshrrev_b32 v45, 4, v2
    v_lshrrev_b32 v46, 2, v44
    v_sub_u32 v46, 0, v46
    v_xor_b32 v46, v46, v45
    v_and_b32 v46, 3, v46
    v_lshlrev_b32 v46, 4, v46
    v_lshlrev_b32 v47, 6, v44
    v_add_u32 v46, v46, v47
    s_lshl_b32 s3, s27, 12
    v_add_u32 v6, s3, v46
    s_lshl_b32 s3, s39, 13
    v_add_u32 v6, s3, v6
    v_bfe_u32 v46, v2, 2, 2
    v_lshl_add_u32 v46, v45, 3, v46
    v_and_b32 v47, 1, v45
    v_lshlrev_b32 v47, 2, v47
    v_add_u32 v48, v46, v47
    v_xor_b32 v47, 4, v47
    v_add_u32 v49, v46, v47
    v_mul_u32_u24 v48, 288, v48
    v_mul_u32_u24 v49, 288, v49
    v_and_b32 v47, 3, v2
    v_lshlrev_b32 v47, 3, v47
    s_mul_i32 s3, s28, 96
    s_add_u32 s3, s3, 16384
    s_mul_i32 s29, s39, 9216
    s_add_u32 s3, s3, s29
    v_add3_u32 v7, v48, v47, s3
    v_add3_u32 v8, v49, v47, s3
    v_add_u32 v9, 69632, v6
    v_add_u32 v10, 69632, v7
    v_add_u32 v11, 69632, v8

    v_mov_b32 v68, 0
    v_mov_b32 v69, 0
    v_mov_b32 v70, 0
    v_mov_b32 v71, 0
    v_mov_b32 v72, 0
    v_mov_b32 v73, 0
    v_mov_b32 v74, 0
    v_mov_b32 v75, 0
    v_mov_b32 v76, 0
    v_mov_b32 v77, 0
    v_mov_b32 v78, 0
    v_mov_b32 v79, 0
    v_mov_b32 v80, 0
    v_mov_b32 v81, 0
    v_mov_b32 v82, 0
    v_mov_b32 v83, 0
    v_mov_b32 v84, 0
    v_mov_b32 v85, 0
    v_mov_b32 v86, 0
    v_mov_b32 v87, 0
    v_mov_b32 v88, 0
    v_mov_b32 v89, 0
    v_mov_b32 v90, 0
    v_mov_b32 v91, 0
    v_mov_b32 v92, 0
    v_mov_b32 v93, 0
    v_mov_b32 v94, 0
    v_mov_b32 v95, 0
    v_mov_b32 v96, 0
    v_mov_b32 v97, 0
    v_mov_b32 v98, 0
    v_mov_b32 v99, 0
    v_mov_b32 v100, 0
    v_mov_b32 v101, 0
    v_mov_b32 v102, 0
    v_mov_b32 v103, 0
    v_mov_b32 v104, 0
    v_mov_b32 v105, 0
    v_mov_b32 v106, 0
    v_mov_b32 v107, 0
    v_mov_b32 v108, 0
    v_mov_b32 v109, 0
    v_mov_b32 v110, 0
    v_mov_b32 v111, 0
    v_mov_b32 v112, 0
    v_mov_b32 v113, 0
    v_mov_b32 v114, 0
    v_mov_b32 v115, 0
    v_mov_b32 v116, 0
    v_mov_b32 v117, 0
    v_mov_b32 v118, 0
    v_mov_b32 v119, 0
    v_mov_b32 v120, 0
    v_mov_b32 v121, 0
    v_mov_b32 v122, 0
    v_mov_b32 v123, 0
    v_mov_b32 v124, 0
    v_mov_b32 v125, 0
    v_mov_b32 v126, 0
    v_mov_b32 v127, 0
    v_mov_b32 v128, 0
    v_mov_b32 v129, 0
    v_mov_b32 v130, 0
    v_mov_b32 v131, 0
    v_mov_b32 v132, 0
    v_mov_b32 v133, 0
    v_mov_b32 v134, 0
    v_mov_b32 v135, 0
    v_mov_b32 v136, 0
    v_mov_b32 v137, 0
    v_mov_b32 v138, 0
    v_mov_b32 v139, 0
    v_mov_b32 v140, 0
    v_mov_b32 v141, 0
    v_mov_b32 v142, 0
    v_mov_b32 v143, 0
    v_mov_b32 v144, 0
    v_mov_b32 v145, 0
    v_mov_b32 v146, 0
    v_mov_b32 v147, 0
    v_mov_b32 v148, 0
    v_mov_b32 v149, 0
    v_mov_b32 v150, 0
    v_mov_b32 v151, 0
    v_mov_b32 v152, 0
    v_mov_b32 v153, 0
    v_mov_b32 v154, 0
    v_mov_b32 v155, 0
    v_mov_b32 v156, 0
    v_mov_b32 v157, 0
    v_mov_b32 v158, 0
    v_mov_b32 v159, 0
    v_mov_b32 v160, 0
    v_mov_b32 v161, 0
    v_mov_b32 v162, 0
    v_mov_b32 v163, 0
    s_waitcnt vmcnt(6)
    s_barrier
    ds_read_b64_tr_b16 v[44:45], v7 offset:0
    ds_read_b64_tr_b16 v[46:47], v8 offset:0

    ds_read_b128 v[12:15], v6 offset:0
    ds_read_b128 v[16:19], v6 offset:1024
    ds_read_b128 v[20:23], v6 offset:2048
    ds_read_b128 v[24:27], v6 offset:3072
    ds_read_b64_tr_b16 v[48:49], v7 offset:32
    ds_read_b64_tr_b16 v[50:51], v8 offset:32

    ds_read_b64_tr_b16 v[52:53], v7 offset:64
    ds_read_b64_tr_b16 v[54:55], v8 offset:64

    ds_read_b64_tr_b16 v[56:57], v7 offset:9216
    ds_read_b64_tr_b16 v[58:59], v8 offset:9216

    ds_read_b64_tr_b16 v[60:61], v7 offset:9248
    ds_read_b64_tr_b16 v[62:63], v8 offset:9248

    ds_read_b64_tr_b16 v[64:65], v7 offset:9280
    ds_read_b64_tr_b16 v[66:67], v8 offset:9280

    s_mov_b32 s38, 3
g1_loop:
    s_waitcnt vmcnt(3)
    s_barrier
    s_waitcnt lgkmcnt(10)
    v_mfma_f32_16x16x32_bf16 v[68:71], v[44:47], v[12:15], v[68:71]
    v_mfma_f32_16x16x32_bf16 v[72:75], v[44:47], v[16:19], v[72:75]
    v_mfma_f32_16x16x32_bf16 v[76:79], v[44:47], v[20:23], v[76:79]
    v_mfma_f32_16x16x32_bf16 v[80:83], v[44:47], v[24:27], v[80:83]
    ds_read_b64_tr_b16 v[44:45], v7 offset:34816
    ds_read_b64_tr_b16 v[46:47], v8 offset:34816

    ds_read_b128 v[28:31], v6 offset:34816
    ds_read_b128 v[32:35], v6 offset:35840
    ds_read_b128 v[36:39], v6 offset:36864
    ds_read_b128 v[40:43], v6 offset:37888
    s_waitcnt lgkmcnt(14)
    v_mfma_f32_16x16x32_bf16 v[84:87], v[48:51], v[12:15], v[84:87]
    v_mfma_f32_16x16x32_bf16 v[88:91], v[48:51], v[16:19], v[88:91]
    v_mfma_f32_16x16x32_bf16 v[92:95], v[48:51], v[20:23], v[92:95]
    v_mfma_f32_16x16x32_bf16 v[96:99], v[48:51], v[24:27], v[96:99]
    ds_read_b64_tr_b16 v[48:49], v7 offset:34848
    ds_read_b64_tr_b16 v[50:51], v8 offset:34848

    s_add_u32 m0, s84, 104448
    s_nop 0
    buffer_load_dwordx4 v3, s[64:67], s76 offen lds
    s_add_u32 s76, s76, s80

    s_waitcnt lgkmcnt(14)
    v_mfma_f32_16x16x32_bf16 v[100:103], v[52:55], v[12:15], v[100:103]
    v_mfma_f32_16x16x32_bf16 v[104:107], v[52:55], v[16:19], v[104:107]
    v_mfma_f32_16x16x32_bf16 v[108:111], v[52:55], v[20:23], v[108:111]
    v_mfma_f32_16x16x32_bf16 v[112:115], v[52:55], v[24:27], v[112:115]
    ds_read_b64_tr_b16 v[52:53], v7 offset:34880
    ds_read_b64_tr_b16 v[54:55], v8 offset:34880

    s_add_u32 m0, s85, 104448
    s_nop 0
    buffer_load_dwordx4 v4, s[68:71], s77 offen lds
    s_add_u32 s77, s77, s81

    s_waitcnt lgkmcnt(14)
    v_mfma_f32_16x16x32_bf16 v[116:119], v[56:59], v[12:15], v[116:119]
    v_mfma_f32_16x16x32_bf16 v[120:123], v[56:59], v[16:19], v[120:123]
    v_mfma_f32_16x16x32_bf16 v[124:127], v[56:59], v[20:23], v[124:127]
    v_mfma_f32_16x16x32_bf16 v[128:131], v[56:59], v[24:27], v[128:131]
    ds_read_b64_tr_b16 v[56:57], v7 offset:44032
    ds_read_b64_tr_b16 v[58:59], v8 offset:44032

    s_add_u32 m0, s86, 104448
    s_nop 0
    buffer_load_dwordx4 v5, s[72:75], s78 offen lds
    s_add_u32 s78, s78, s82

    s_waitcnt lgkmcnt(14)
    v_mfma_f32_16x16x32_bf16 v[132:135], v[60:63], v[12:15], v[132:135]
    v_mfma_f32_16x16x32_bf16 v[136:139], v[60:63], v[16:19], v[136:139]
    v_mfma_f32_16x16x32_bf16 v[140:143], v[60:63], v[20:23], v[140:143]
    v_mfma_f32_16x16x32_bf16 v[144:147], v[60:63], v[24:27], v[144:147]
    ds_read_b64_tr_b16 v[60:61], v7 offset:44064
    ds_read_b64_tr_b16 v[62:63], v8 offset:44064

    s_waitcnt lgkmcnt(14)
    v_mfma_f32_16x16x32_bf16 v[148:151], v[64:67], v[12:15], v[148:151]
    v_mfma_f32_16x16x32_bf16 v[152:155], v[64:67], v[16:19], v[152:155]
    v_mfma_f32_16x16x32_bf16 v[156:159], v[64:67], v[20:23], v[156:159]
    v_mfma_f32_16x16x32_bf16 v[160:163], v[64:67], v[24:27], v[160:163]
    ds_read_b64_tr_b16 v[64:65], v7 offset:44096
    ds_read_b64_tr_b16 v[66:67], v8 offset:44096

    s_waitcnt vmcnt(3)
    s_barrier
    s_waitcnt lgkmcnt(10)
    v_mfma_f32_16x16x32_bf16 v[68:71], v[44:47], v[28:31], v[68:71]
    v_mfma_f32_16x16x32_bf16 v[72:75], v[44:47], v[32:35], v[72:75]
    v_mfma_f32_16x16x32_bf16 v[76:79], v[44:47], v[36:39], v[76:79]
    v_mfma_f32_16x16x32_bf16 v[80:83], v[44:47], v[40:43], v[80:83]
    ds_read_b64_tr_b16 v[44:45], v10 offset:0
    ds_read_b64_tr_b16 v[46:47], v11 offset:0

    ds_read_b128 v[12:15], v9 offset:0
    ds_read_b128 v[16:19], v9 offset:1024
    ds_read_b128 v[20:23], v9 offset:2048
    ds_read_b128 v[24:27], v9 offset:3072
    s_waitcnt lgkmcnt(14)
    v_mfma_f32_16x16x32_bf16 v[84:87], v[48:51], v[28:31], v[84:87]
    v_mfma_f32_16x16x32_bf16 v[88:91], v[48:51], v[32:35], v[88:91]
    v_mfma_f32_16x16x32_bf16 v[92:95], v[48:51], v[36:39], v[92:95]
    v_mfma_f32_16x16x32_bf16 v[96:99], v[48:51], v[40:43], v[96:99]
    ds_read_b64_tr_b16 v[48:49], v10 offset:32
    ds_read_b64_tr_b16 v[50:51], v11 offset:32

    s_add_u32 m0, s84, 0
    s_nop 0
    buffer_load_dwordx4 v3, s[64:67], s76 offen lds
    s_add_u32 s76, s76, s80

    s_waitcnt lgkmcnt(14)
    v_mfma_f32_16x16x32_bf16 v[100:103], v[52:55], v[28:31], v[100:103]
    v_mfma_f32_16x16x32_bf16 v[104:107], v[52:55], v[32:35], v[104:107]
    v_mfma_f32_16x16x32_bf16 v[108:111], v[52:55], v[36:39], v[108:111]
    v_mfma_f32_16x16x32_bf16 v[112:115], v[52:55], v[40:43], v[112:115]
    ds_read_b64_tr_b16 v[52:53], v10 offset:64
    ds_read_b64_tr_b16 v[54:55], v11 offset:64

    s_add_u32 m0, s85, 0
    s_nop 0
    buffer_load_dwordx4 v4, s[68:71], s77 offen lds
    s_add_u32 s77, s77, s81

    s_waitcnt lgkmcnt(14)
    v_mfma_f32_16x16x32_bf16 v[116:119], v[56:59], v[28:31], v[116:119]
    v_mfma_f32_16x16x32_bf16 v[120:123], v[56:59], v[32:35], v[120:123]
    v_mfma_f32_16x16x32_bf16 v[124:127], v[56:59], v[36:39], v[124:127]
    v_mfma_f32_16x16x32_bf16 v[128:131], v[56:59], v[40:43], v[128:131]
    ds_read_b64_tr_b16 v[56:57], v10 offset:9216
    ds_read_b64_tr_b16 v[58:59], v11 offset:9216

    s_add_u32 m0, s86, 0
    s_nop 0
    buffer_load_dwordx4 v5, s[72:75], s78 offen lds
    s_add_u32 s78, s78, s82

    s_waitcnt lgkmcnt(14)
    v_mfma_f32_16x16x32_bf16 v[132:135], v[60:63], v[28:31], v[132:135]
    v_mfma_f32_16x16x32_bf16 v[136:139], v[60:63], v[32:35], v[136:139]
    v_mfma_f32_16x16x32_bf16 v[140:143], v[60:63], v[36:39], v[140:143]
    v_mfma_f32_16x16x32_bf16 v[144:147], v[60:63], v[40:43], v[144:147]
    ds_read_b64_tr_b16 v[60:61], v10 offset:9248
    ds_read_b64_tr_b16 v[62:63], v11 offset:9248

    s_waitcnt lgkmcnt(14)
    v_mfma_f32_16x16x32_bf16 v[148:151], v[64:67], v[28:31], v[148:151]
    v_mfma_f32_16x16x32_bf16 v[152:155], v[64:67], v[32:35], v[152:155]
    v_mfma_f32_16x16x32_bf16 v[156:159], v[64:67], v[36:39], v[156:159]
    v_mfma_f32_16x16x32_bf16 v[160:163], v[64:67], v[40:43], v[160:163]
    ds_read_b64_tr_b16 v[64:65], v10 offset:9280
    ds_read_b64_tr_b16 v[66:67], v11 offset:9280

    s_waitcnt vmcnt(3)
    s_barrier
    s_waitcnt lgkmcnt(10)
    v_mfma_f32_16x16x32_bf16 v[68:71], v[44:47], v[12:15], v[68:71]
    v_mfma_f32_16x16x32_bf16 v[72:75], v[44:47], v[16:19], v[72:75]
    v_mfma_f32_16x16x32_bf16 v[76:79], v[44:47], v[20:23], v[76:79]
    v_mfma_f32_16x16x32_bf16 v[80:83], v[44:47], v[24:27], v[80:83]
    ds_read_b64_tr_b16 v[44:45], v10 offset:34816
    ds_read_b64_tr_b16 v[46:47], v11 offset:34816

    ds_read_b128 v[28:31], v9 offset:34816
    ds_read_b128 v[32:35], v9 offset:35840
    ds_read_b128 v[36:39], v9 offset:36864
    ds_read_b128 v[40:43], v9 offset:37888
    s_waitcnt lgkmcnt(14)
    v_mfma_f32_16x16x32_bf16 v[84:87], v[48:51], v[12:15], v[84:87]
    v_mfma_f32_16x16x32_bf16 v[88:91], v[48:51], v[16:19], v[88:91]
    v_mfma_f32_16x16x32_bf16 v[92:95], v[48:51], v[20:23], v[92:95]
    v_mfma_f32_16x16x32_bf16 v[96:99], v[48:51], v[24:27], v[96:99]
    ds_read_b64_tr_b16 v[48:49], v10 offset:34848
    ds_read_b64_tr_b16 v[50:51], v11 offset:34848

    s_add_u32 m0, s84, 34816
    s_nop 0
    buffer_load_dwordx4 v3, s[64:67], s76 offen lds
    s_add_u32 s76, s76, s80

    s_waitcnt lgkmcnt(14)
    v_mfma_f32_16x16x32_bf16 v[100:103], v[52:55], v[12:15], v[100:103]
    v_mfma_f32_16x16x32_bf16 v[104:107], v[52:55], v[16:19], v[104:107]
    v_mfma_f32_16x16x32_bf16 v[108:111], v[52:55], v[20:23], v[108:111]
    v_mfma_f32_16x16x32_bf16 v[112:115], v[52:55], v[24:27], v[112:115]
    ds_read_b64_tr_b16 v[52:53], v10 offset:34880
    ds_read_b64_tr_b16 v[54:55], v11 offset:34880

    s_add_u32 m0, s85, 34816
    s_nop 0
    buffer_load_dwordx4 v4, s[68:71], s77 offen lds
    s_add_u32 s77, s77, s81

    s_waitcnt lgkmcnt(14)
    v_mfma_f32_16x16x32_bf16 v[116:119], v[56:59], v[12:15], v[116:119]
    v_mfma_f32_16x16x32_bf16 v[120:123], v[56:59], v[16:19], v[120:123]
    v_mfma_f32_16x16x32_bf16 v[124:127], v[56:59], v[20:23], v[124:127]
    v_mfma_f32_16x16x32_bf16 v[128:131], v[56:59], v[24:27], v[128:131]
    ds_read_b64_tr_b16 v[56:57], v10 offset:44032
    ds_read_b64_tr_b16 v[58:59], v11 offset:44032

    s_add_u32 m0, s86, 34816
    s_nop 0
    buffer_load_dwordx4 v5, s[72:75], s78 offen lds
    s_add_u32 s78, s78, s82

    s_waitcnt lgkmcnt(14)
    v_mfma_f32_16x16x32_bf16 v[132:135], v[60:63], v[12:15], v[132:135]
    v_mfma_f32_16x16x32_bf16 v[136:139], v[60:63], v[16:19], v[136:139]
    v_mfma_f32_16x16x32_bf16 v[140:143], v[60:63], v[20:23], v[140:143]
    v_mfma_f32_16x16x32_bf16 v[144:147], v[60:63], v[24:27], v[144:147]
    ds_read_b64_tr_b16 v[60:61], v10 offset:44064
    ds_read_b64_tr_b16 v[62:63], v11 offset:44064

    s_waitcnt lgkmcnt(14)
    v_mfma_f32_16x16x32_bf16 v[148:151], v[64:67], v[12:15], v[148:151]
    v_mfma_f32_16x16x32_bf16 v[152:155], v[64:67], v[16:19], v[152:155]
    v_mfma_f32_16x16x32_bf16 v[156:159], v[64:67], v[20:23], v[156:159]
    v_mfma_f32_16x16x32_bf16 v[160:163], v[64:67], v[24:27], v[160:163]
    ds_read_b64_tr_b16 v[64:65], v10 offset:44096
    ds_read_b64_tr_b16 v[66:67], v11 offset:44096

    s_waitcnt vmcnt(3)
    s_barrier
    s_waitcnt lgkmcnt(10)
    v_mfma_f32_16x16x32_bf16 v[68:71], v[44:47], v[28:31], v[68:71]
    v_mfma_f32_16x16x32_bf16 v[72:75], v[44:47], v[32:35], v[72:75]
    v_mfma_f32_16x16x32_bf16 v[76:79], v[44:47], v[36:39], v[76:79]
    v_mfma_f32_16x16x32_bf16 v[80:83], v[44:47], v[40:43], v[80:83]
    ds_read_b64_tr_b16 v[44:45], v7 offset:0
    ds_read_b64_tr_b16 v[46:47], v8 offset:0

    ds_read_b128 v[12:15], v6 offset:0
    ds_read_b128 v[16:19], v6 offset:1024
    ds_read_b128 v[20:23], v6 offset:2048
    ds_read_b128 v[24:27], v6 offset:3072
    s_waitcnt lgkmcnt(14)
    v_mfma_f32_16x16x32_bf16 v[84:87], v[48:51], v[28:31], v[84:87]
    v_mfma_f32_16x16x32_bf16 v[88:91], v[48:51], v[32:35], v[88:91]
    v_mfma_f32_16x16x32_bf16 v[92:95], v[48:51], v[36:39], v[92:95]
    v_mfma_f32_16x16x32_bf16 v[96:99], v[48:51], v[40:43], v[96:99]
    ds_read_b64_tr_b16 v[48:49], v7 offset:32
    ds_read_b64_tr_b16 v[50:51], v8 offset:32

    s_add_u32 m0, s84, 69632
    s_nop 0
    buffer_load_dwordx4 v3, s[64:67], s76 offen lds
    s_add_u32 s76, s76, s80

    s_waitcnt lgkmcnt(14)
    v_mfma_f32_16x16x32_bf16 v[100:103], v[52:55], v[28:31], v[100:103]
    v_mfma_f32_16x16x32_bf16 v[104:107], v[52:55], v[32:35], v[104:107]
    v_mfma_f32_16x16x32_bf16 v[108:111], v[52:55], v[36:39], v[108:111]
    v_mfma_f32_16x16x32_bf16 v[112:115], v[52:55], v[40:43], v[112:115]
    ds_read_b64_tr_b16 v[52:53], v7 offset:64
    ds_read_b64_tr_b16 v[54:55], v8 offset:64

    s_add_u32 m0, s85, 69632
    s_nop 0
    buffer_load_dwordx4 v4, s[68:71], s77 offen lds
    s_add_u32 s77, s77, s81

    s_waitcnt lgkmcnt(14)
    v_mfma_f32_16x16x32_bf16 v[116:119], v[56:59], v[28:31], v[116:119]
    v_mfma_f32_16x16x32_bf16 v[120:123], v[56:59], v[32:35], v[120:123]
    v_mfma_f32_16x16x32_bf16 v[124:127], v[56:59], v[36:39], v[124:127]
    v_mfma_f32_16x16x32_bf16 v[128:131], v[56:59], v[40:43], v[128:131]
    ds_read_b64_tr_b16 v[56:57], v7 offset:9216
    ds_read_b64_tr_b16 v[58:59], v8 offset:9216

    s_add_u32 m0, s86, 69632
    s_nop 0
    buffer_load_dwordx4 v5, s[72:75], s78 offen lds
    s_add_u32 s78, s78, s82

    s_waitcnt lgkmcnt(14)
    v_mfma_f32_16x16x32_bf16 v[132:135], v[60:63], v[28:31], v[132:135]
    v_mfma_f32_16x16x32_bf16 v[136:139], v[60:63], v[32:35], v[136:139]
    v_mfma_f32_16x16x32_bf16 v[140:143], v[60:63], v[36:39], v[140:143]
    v_mfma_f32_16x16x32_bf16 v[144:147], v[60:63], v[40:43], v[144:147]
    ds_read_b64_tr_b16 v[60:61], v7 offset:9248
    ds_read_b64_tr_b16 v[62:63], v8 offset:9248

    s_waitcnt lgkmcnt(14)
    v_mfma_f32_16x16x32_bf16 v[148:151], v[64:67], v[28:31], v[148:151]
    v_mfma_f32_16x16x32_bf16 v[152:155], v[64:67], v[32:35], v[152:155]
    v_mfma_f32_16x16x32_bf16 v[156:159], v[64:67], v[36:39], v[156:159]
    v_mfma_f32_16x16x32_bf16 v[160:163], v[64:67], v[40:43], v[160:163]
    ds_read_b64_tr_b16 v[64:65], v7 offset:9280
    ds_read_b64_tr_b16 v[66:67], v8 offset:9280

    s_sub_u32 s38, s38, 1
    s_cmp_lg_u32 s38, 0
    s_cbranch_scc1 g1_loop
    s_waitcnt vmcnt(3)
    s_barrier
    s_waitcnt lgkmcnt(10)
    v_mfma_f32_16x16x32_bf16 v[68:71], v[44:47], v[12:15], v[68:71]
    v_mfma_f32_16x16x32_bf16 v[72:75], v[44:47], v[16:19], v[72:75]
    v_mfma_f32_16x16x32_bf16 v[76:79], v[44:47], v[20:23], v[76:79]
    v_mfma_f32_16x16x32_bf16 v[80:83], v[44:47], v[24:27], v[80:83]
    ds_read_b64_tr_b16 v[44:45], v7 offset:34816
    ds_read_b64_tr_b16 v[46:47], v8 offset:34816

    ds_read_b128 v[28:31], v6 offset:34816
    ds_read_b128 v[32:35], v6 offset:35840
    ds_read_b128 v[36:39], v6 offset:36864
    ds_read_b128 v[40:43], v6 offset:37888
    s_waitcnt lgkmcnt(14)
    v_mfma_f32_16x16x32_bf16 v[84:87], v[48:51], v[12:15], v[84:87]
    v_mfma_f32_16x16x32_bf16 v[88:91], v[48:51], v[16:19], v[88:91]
    v_mfma_f32_16x16x32_bf16 v[92:95], v[48:51], v[20:23], v[92:95]
    v_mfma_f32_16x16x32_bf16 v[96:99], v[48:51], v[24:27], v[96:99]
    ds_read_b64_tr_b16 v[48:49], v7 offset:34848
    ds_read_b64_tr_b16 v[50:51], v8 offset:34848

    s_add_u32 m0, s84, 104448
    s_nop 0
    buffer_load_dwordx4 v3, s[64:67], s76 offen lds
    s_add_u32 s76, s76, s80

    s_waitcnt lgkmcnt(14)
    v_mfma_f32_16x16x32_bf16 v[100:103], v[52:55], v[12:15], v[100:103]
    v_mfma_f32_16x16x32_bf16 v[104:107], v[52:55], v[16:19], v[104:107]
    v_mfma_f32_16x16x32_bf16 v[108:111], v[52:55], v[20:23], v[108:111]
    v_mfma_f32_16x16x32_bf16 v[112:115], v[52:55], v[24:27], v[112:115]
    ds_read_b64_tr_b16 v[52:53], v7 offset:34880
    ds_read_b64_tr_b16 v[54:55], v8 offset:34880

    s_add_u32 m0, s85, 104448
    s_nop 0
    buffer_load_dwordx4 v4, s[68:71], s77 offen lds
    s_add_u32 s77, s77, s81

    s_waitcnt lgkmcnt(14)
    v_mfma_f32_16x16x32_bf16 v[116:119], v[56:59], v[12:15], v[116:119]
    v_mfma_f32_16x16x32_bf16 v[120:123], v[56:59], v[16:19], v[120:123]
    v_mfma_f32_16x16x32_bf16 v[124:127], v[56:59], v[20:23], v[124:127]
    v_mfma_f32_16x16x32_bf16 v[128:131], v[56:59], v[24:27], v[128:131]
    ds_read_b64_tr_b16 v[56:57], v7 offset:44032
    ds_read_b64_tr_b16 v[58:59], v8 offset:44032

    s_add_u32 m0, s86, 104448
    s_nop 0
    buffer_load_dwordx4 v5, s[72:75], s78 offen lds
    s_add_u32 s78, s78, s82

    s_waitcnt lgkmcnt(14)
    v_mfma_f32_16x16x32_bf16 v[132:135], v[60:63], v[12:15], v[132:135]
    v_mfma_f32_16x16x32_bf16 v[136:139], v[60:63], v[16:19], v[136:139]
    v_mfma_f32_16x16x32_bf16 v[140:143], v[60:63], v[20:23], v[140:143]
    v_mfma_f32_16x16x32_bf16 v[144:147], v[60:63], v[24:27], v[144:147]
    ds_read_b64_tr_b16 v[60:61], v7 offset:44064
    ds_read_b64_tr_b16 v[62:63], v8 offset:44064

    s_waitcnt lgkmcnt(14)
    v_mfma_f32_16x16x32_bf16 v[148:151], v[64:67], v[12:15], v[148:151]
    v_mfma_f32_16x16x32_bf16 v[152:155], v[64:67], v[16:19], v[152:155]
    v_mfma_f32_16x16x32_bf16 v[156:159], v[64:67], v[20:23], v[156:159]
    v_mfma_f32_16x16x32_bf16 v[160:163], v[64:67], v[24:27], v[160:163]
    ds_read_b64_tr_b16 v[64:65], v7 offset:44096
    ds_read_b64_tr_b16 v[66:67], v8 offset:44096

    s_waitcnt vmcnt(3)
    s_barrier
    s_waitcnt lgkmcnt(10)
    v_mfma_f32_16x16x32_bf16 v[68:71], v[44:47], v[28:31], v[68:71]
    v_mfma_f32_16x16x32_bf16 v[72:75], v[44:47], v[32:35], v[72:75]
    v_mfma_f32_16x16x32_bf16 v[76:79], v[44:47], v[36:39], v[76:79]
    v_mfma_f32_16x16x32_bf16 v[80:83], v[44:47], v[40:43], v[80:83]
    ds_read_b64_tr_b16 v[44:45], v10 offset:0
    ds_read_b64_tr_b16 v[46:47], v11 offset:0

    ds_read_b128 v[12:15], v9 offset:0
    ds_read_b128 v[16:19], v9 offset:1024
    ds_read_b128 v[20:23], v9 offset:2048
    ds_read_b128 v[24:27], v9 offset:3072
    s_waitcnt lgkmcnt(14)
    v_mfma_f32_16x16x32_bf16 v[84:87], v[48:51], v[28:31], v[84:87]
    v_mfma_f32_16x16x32_bf16 v[88:91], v[48:51], v[32:35], v[88:91]
    v_mfma_f32_16x16x32_bf16 v[92:95], v[48:51], v[36:39], v[92:95]
    v_mfma_f32_16x16x32_bf16 v[96:99], v[48:51], v[40:43], v[96:99]
    ds_read_b64_tr_b16 v[48:49], v10 offset:32
    ds_read_b64_tr_b16 v[50:51], v11 offset:32

    s_add_u32 m0, s84, 0
    s_nop 0
    buffer_load_dwordx4 v3, s[64:67], s76 offen lds
    s_add_u32 s76, s76, s80

    s_waitcnt lgkmcnt(14)
    v_mfma_f32_16x16x32_bf16 v[100:103], v[52:55], v[28:31], v[100:103]
    v_mfma_f32_16x16x32_bf16 v[104:107], v[52:55], v[32:35], v[104:107]
    v_mfma_f32_16x16x32_bf16 v[108:111], v[52:55], v[36:39], v[108:111]
    v_mfma_f32_16x16x32_bf16 v[112:115], v[52:55], v[40:43], v[112:115]
    ds_read_b64_tr_b16 v[52:53], v10 offset:64
    ds_read_b64_tr_b16 v[54:55], v11 offset:64

    s_add_u32 m0, s85, 0
    s_nop 0
    buffer_load_dwordx4 v4, s[68:71], s77 offen lds
    s_add_u32 s77, s77, s81

    s_waitcnt lgkmcnt(14)
    v_mfma_f32_16x16x32_bf16 v[116:119], v[56:59], v[28:31], v[116:119]
    v_mfma_f32_16x16x32_bf16 v[120:123], v[56:59], v[32:35], v[120:123]
    v_mfma_f32_16x16x32_bf16 v[124:127], v[56:59], v[36:39], v[124:127]
    v_mfma_f32_16x16x32_bf16 v[128:131], v[56:59], v[40:43], v[128:131]
    ds_read_b64_tr_b16 v[56:57], v10 offset:9216
    ds_read_b64_tr_b16 v[58:59], v11 offset:9216

    s_add_u32 m0, s86, 0
    s_nop 0
    buffer_load_dwordx4 v5, s[72:75], s78 offen lds
    s_add_u32 s78, s78, s82

    s_waitcnt lgkmcnt(14)
    v_mfma_f32_16x16x32_bf16 v[132:135], v[60:63], v[28:31], v[132:135]
    v_mfma_f32_16x16x32_bf16 v[136:139], v[60:63], v[32:35], v[136:139]
    v_mfma_f32_16x16x32_bf16 v[140:143], v[60:63], v[36:39], v[140:143]
    v_mfma_f32_16x16x32_bf16 v[144:147], v[60:63], v[40:43], v[144:147]
    ds_read_b64_tr_b16 v[60:61], v10 offset:9248
    ds_read_b64_tr_b16 v[62:63], v11 offset:9248

    s_waitcnt lgkmcnt(14)
    v_mfma_f32_16x16x32_bf16 v[148:151], v[64:67], v[28:31], v[148:151]
    v_mfma_f32_16x16x32_bf16 v[152:155], v[64:67], v[32:35], v[152:155]
    v_mfma_f32_16x16x32_bf16 v[156:159], v[64:67], v[36:39], v[156:159]
    v_mfma_f32_16x16x32_bf16 v[160:163], v[64:67], v[40:43], v[160:163]
    ds_read_b64_tr_b16 v[64:65], v10 offset:9280
    ds_read_b64_tr_b16 v[66:67], v11 offset:9280

    s_waitcnt vmcnt(3)
    s_barrier
    s_waitcnt lgkmcnt(10)
    v_mfma_f32_16x16x32_bf16 v[68:71], v[44:47], v[12:15], v[68:71]
    v_mfma_f32_16x16x32_bf16 v[72:75], v[44:47], v[16:19], v[72:75]
    v_mfma_f32_16x16x32_bf16 v[76:79], v[44:47], v[20:23], v[76:79]
    v_mfma_f32_16x16x32_bf16 v[80:83], v[44:47], v[24:27], v[80:83]
    ds_read_b64_tr_b16 v[44:45], v10 offset:34816
    ds_read_b64_tr_b16 v[46:47], v11 offset:34816

    ds_read_b128 v[28:31], v9 offset:34816
    ds_read_b128 v[32:35], v9 offset:35840
    ds_read_b128 v[36:39], v9 offset:36864
    ds_read_b128 v[40:43], v9 offset:37888
    s_waitcnt lgkmcnt(14)
    v_mfma_f32_16x16x32_bf16 v[84:87], v[48:51], v[12:15], v[84:87]
    v_mfma_f32_16x16x32_bf16 v[88:91], v[48:51], v[16:19], v[88:91]
    v_mfma_f32_16x16x32_bf16 v[92:95], v[48:51], v[20:23], v[92:95]
    v_mfma_f32_16x16x32_bf16 v[96:99], v[48:51], v[24:27], v[96:99]
    ds_read_b64_tr_b16 v[48:49], v10 offset:34848
    ds_read_b64_tr_b16 v[50:51], v11 offset:34848

    s_add_u32 m0, s84, 34816
    s_nop 0
    buffer_load_dwordx4 v3, s[64:67], s76 offen lds
    s_add_u32 s76, s76, s80

    s_waitcnt lgkmcnt(14)
    v_mfma_f32_16x16x32_bf16 v[100:103], v[52:55], v[12:15], v[100:103]
    v_mfma_f32_16x16x32_bf16 v[104:107], v[52:55], v[16:19], v[104:107]
    v_mfma_f32_16x16x32_bf16 v[108:111], v[52:55], v[20:23], v[108:111]
    v_mfma_f32_16x16x32_bf16 v[112:115], v[52:55], v[24:27], v[112:115]
    ds_read_b64_tr_b16 v[52:53], v10 offset:34880
    ds_read_b64_tr_b16 v[54:55], v11 offset:34880

    s_add_u32 m0, s85, 34816
    s_nop 0
    buffer_load_dwordx4 v4, s[68:71], s77 offen lds
    s_add_u32 s77, s77, s81

    s_waitcnt lgkmcnt(14)
    v_mfma_f32_16x16x32_bf16 v[116:119], v[56:59], v[12:15], v[116:119]
    v_mfma_f32_16x16x32_bf16 v[120:123], v[56:59], v[16:19], v[120:123]
    v_mfma_f32_16x16x32_bf16 v[124:127], v[56:59], v[20:23], v[124:127]
    v_mfma_f32_16x16x32_bf16 v[128:131], v[56:59], v[24:27], v[128:131]
    ds_read_b64_tr_b16 v[56:57], v10 offset:44032
    ds_read_b64_tr_b16 v[58:59], v11 offset:44032

    s_add_u32 m0, s86, 34816
    s_nop 0
    buffer_load_dwordx4 v5, s[72:75], s78 offen lds
    s_add_u32 s78, s78, s82

    s_waitcnt lgkmcnt(14)
    v_mfma_f32_16x16x32_bf16 v[132:135], v[60:63], v[12:15], v[132:135]
    v_mfma_f32_16x16x32_bf16 v[136:139], v[60:63], v[16:19], v[136:139]
    v_mfma_f32_16x16x32_bf16 v[140:143], v[60:63], v[20:23], v[140:143]
    v_mfma_f32_16x16x32_bf16 v[144:147], v[60:63], v[24:27], v[144:147]
    ds_read_b64_tr_b16 v[60:61], v10 offset:44064
    ds_read_b64_tr_b16 v[62:63], v11 offset:44064

    s_waitcnt lgkmcnt(14)
    v_mfma_f32_16x16x32_bf16 v[148:151], v[64:67], v[12:15], v[148:151]
    v_mfma_f32_16x16x32_bf16 v[152:155], v[64:67], v[16:19], v[152:155]
    v_mfma_f32_16x16x32_bf16 v[156:159], v[64:67], v[20:23], v[156:159]
    v_mfma_f32_16x16x32_bf16 v[160:163], v[64:67], v[24:27], v[160:163]
    ds_read_b64_tr_b16 v[64:65], v10 offset:44096
    ds_read_b64_tr_b16 v[66:67], v11 offset:44096

    s_waitcnt vmcnt(3)
    s_barrier
    s_waitcnt lgkmcnt(10)
    v_mfma_f32_16x16x32_bf16 v[68:71], v[44:47], v[28:31], v[68:71]
    v_mfma_f32_16x16x32_bf16 v[72:75], v[44:47], v[32:35], v[72:75]
    v_mfma_f32_16x16x32_bf16 v[76:79], v[44:47], v[36:39], v[76:79]
    v_mfma_f32_16x16x32_bf16 v[80:83], v[44:47], v[40:43], v[80:83]
    ds_read_b64_tr_b16 v[44:45], v7 offset:0
    ds_read_b64_tr_b16 v[46:47], v8 offset:0

    ds_read_b128 v[12:15], v6 offset:0
    ds_read_b128 v[16:19], v6 offset:1024
    ds_read_b128 v[20:23], v6 offset:2048
    ds_read_b128 v[24:27], v6 offset:3072
    s_waitcnt lgkmcnt(14)
    v_mfma_f32_16x16x32_bf16 v[84:87], v[48:51], v[28:31], v[84:87]
    v_mfma_f32_16x16x32_bf16 v[88:91], v[48:51], v[32:35], v[88:91]
    v_mfma_f32_16x16x32_bf16 v[92:95], v[48:51], v[36:39], v[92:95]
    v_mfma_f32_16x16x32_bf16 v[96:99], v[48:51], v[40:43], v[96:99]
    ds_read_b64_tr_b16 v[48:49], v7 offset:32
    ds_read_b64_tr_b16 v[50:51], v8 offset:32

    s_waitcnt lgkmcnt(14)
    v_mfma_f32_16x16x32_bf16 v[100:103], v[52:55], v[28:31], v[100:103]
    v_mfma_f32_16x16x32_bf16 v[104:107], v[52:55], v[32:35], v[104:107]
    v_mfma_f32_16x16x32_bf16 v[108:111], v[52:55], v[36:39], v[108:111]
    v_mfma_f32_16x16x32_bf16 v[112:115], v[52:55], v[40:43], v[112:115]
    ds_read_b64_tr_b16 v[52:53], v7 offset:64
    ds_read_b64_tr_b16 v[54:55], v8 offset:64

    s_waitcnt lgkmcnt(14)
    v_mfma_f32_16x16x32_bf16 v[116:119], v[56:59], v[28:31], v[116:119]
    v_mfma_f32_16x16x32_bf16 v[120:123], v[56:59], v[32:35], v[120:123]
    v_mfma_f32_16x16x32_bf16 v[124:127], v[56:59], v[36:39], v[124:127]
    v_mfma_f32_16x16x32_bf16 v[128:131], v[56:59], v[40:43], v[128:131]
    ds_read_b64_tr_b16 v[56:57], v7 offset:9216
    ds_read_b64_tr_b16 v[58:59], v8 offset:9216

    s_waitcnt lgkmcnt(14)
    v_mfma_f32_16x16x32_bf16 v[132:135], v[60:63], v[28:31], v[132:135]
    v_mfma_f32_16x16x32_bf16 v[136:139], v[60:63], v[32:35], v[136:139]
    v_mfma_f32_16x16x32_bf16 v[140:143], v[60:63], v[36:39], v[140:143]
    v_mfma_f32_16x16x32_bf16 v[144:147], v[60:63], v[40:43], v[144:147]
    ds_read_b64_tr_b16 v[60:61], v7 offset:9248
    ds_read_b64_tr_b16 v[62:63], v8 offset:9248

    s_waitcnt lgkmcnt(14)
    v_mfma_f32_16x16x32_bf16 v[148:151], v[64:67], v[28:31], v[148:151]
    v_mfma_f32_16x16x32_bf16 v[152:155], v[64:67], v[32:35], v[152:155]
    v_mfma_f32_16x16x32_bf16 v[156:159], v[64:67], v[36:39], v[156:159]
    v_mfma_f32_16x16x32_bf16 v[160:163], v[64:67], v[40:43], v[160:163]
    ds_read_b64_tr_b16 v[64:65], v7 offset:9280
    ds_read_b64_tr_b16 v[66:67], v8 offset:9280

    s_waitcnt vmcnt(0)
    s_barrier
    s_waitcnt lgkmcnt(10)
    v_mfma_f32_16x16x32_bf16 v[68:71], v[44:47], v[12:15], v[68:71]
    v_mfma_f32_16x16x32_bf16 v[72:75], v[44:47], v[16:19], v[72:75]
    v_mfma_f32_16x16x32_bf16 v[76:79], v[44:47], v[20:23], v[76:79]
    v_mfma_f32_16x16x32_bf16 v[80:83], v[44:47], v[24:27], v[80:83]
    ds_read_b64_tr_b16 v[44:45], v7 offset:34816
    ds_read_b64_tr_b16 v[46:47], v8 offset:34816

    ds_read_b128 v[28:31], v6 offset:34816
    ds_read_b128 v[32:35], v6 offset:35840
    ds_read_b128 v[36:39], v6 offset:36864
    ds_read_b128 v[40:43], v6 offset:37888
    s_waitcnt lgkmcnt(14)
    v_mfma_f32_16x16x32_bf16 v[84:87], v[48:51], v[12:15], v[84:87]
    v_mfma_f32_16x16x32_bf16 v[88:91], v[48:51], v[16:19], v[88:91]
    v_mfma_f32_16x16x32_bf16 v[92:95], v[48:51], v[20:23], v[92:95]
    v_mfma_f32_16x16x32_bf16 v[96:99], v[48:51], v[24:27], v[96:99]
    ds_read_b64_tr_b16 v[48:49], v7 offset:34848
    ds_read_b64_tr_b16 v[50:51], v8 offset:34848

    s_waitcnt lgkmcnt(14)
    v_mfma_f32_16x16x32_bf16 v[100:103], v[52:55], v[12:15], v[100:103]
    v_mfma_f32_16x16x32_bf16 v[104:107], v[52:55], v[16:19], v[104:107]
    v_mfma_f32_16x16x32_bf16 v[108:111], v[52:55], v[20:23], v[108:111]
    v_mfma_f32_16x16x32_bf16 v[112:115], v[52:55], v[24:27], v[112:115]
    ds_read_b64_tr_b16 v[52:53], v7 offset:34880
    ds_read_b64_tr_b16 v[54:55], v8 offset:34880

    s_waitcnt lgkmcnt(14)
    v_mfma_f32_16x16x32_bf16 v[116:119], v[56:59], v[12:15], v[116:119]
    v_mfma_f32_16x16x32_bf16 v[120:123], v[56:59], v[16:19], v[120:123]
    v_mfma_f32_16x16x32_bf16 v[124:127], v[56:59], v[20:23], v[124:127]
    v_mfma_f32_16x16x32_bf16 v[128:131], v[56:59], v[24:27], v[128:131]
    ds_read_b64_tr_b16 v[56:57], v7 offset:44032
    ds_read_b64_tr_b16 v[58:59], v8 offset:44032

    s_waitcnt lgkmcnt(14)
    v_mfma_f32_16x16x32_bf16 v[132:135], v[60:63], v[12:15], v[132:135]
    v_mfma_f32_16x16x32_bf16 v[136:139], v[60:63], v[16:19], v[136:139]
    v_mfma_f32_16x16x32_bf16 v[140:143], v[60:63], v[20:23], v[140:143]
    v_mfma_f32_16x16x32_bf16 v[144:147], v[60:63], v[24:27], v[144:147]
    ds_read_b64_tr_b16 v[60:61], v7 offset:44064
    ds_read_b64_tr_b16 v[62:63], v8 offset:44064

    s_waitcnt lgkmcnt(14)
    v_mfma_f32_16x16x32_bf16 v[148:151], v[64:67], v[12:15], v[148:151]
    v_mfma_f32_16x16x32_bf16 v[152:155], v[64:67], v[16:19], v[152:155]
    v_mfma_f32_16x16x32_bf16 v[156:159], v[64:67], v[20:23], v[156:159]
    v_mfma_f32_16x16x32_bf16 v[160:163], v[64:67], v[24:27], v[160:163]
    ds_read_b64_tr_b16 v[64:65], v7 offset:44096
    ds_read_b64_tr_b16 v[66:67], v8 offset:44096

    s_waitcnt lgkmcnt(0)
    v_mfma_f32_16x16x32_bf16 v[68:71], v[44:47], v[28:31], v[68:71]
    v_mfma_f32_16x16x32_bf16 v[72:75], v[44:47], v[32:35], v[72:75]
    v_mfma_f32_16x16x32_bf16 v[76:79], v[44:47], v[36:39], v[76:79]
    v_mfma_f32_16x16x32_bf16 v[80:83], v[44:47], v[40:43], v[80:83]
    v_mfma_f32_16x16x32_bf16 v[84:87], v[48:51], v[28:31], v[84:87]
    v_mfma_f32_16x16x32_bf16 v[88:91], v[48:51], v[32:35], v[88:91]
    v_mfma_f32_16x16x32_bf16 v[92:95], v[48:51], v[36:39], v[92:95]
    v_mfma_f32_16x16x32_bf16 v[96:99], v[48:51], v[40:43], v[96:99]
    v_mfma_f32_16x16x32_bf16 v[100:103], v[52:55], v[28:31], v[100:103]
    v_mfma_f32_16x16x32_bf16 v[104:107], v[52:55], v[32:35], v[104:107]
    v_mfma_f32_16x16x32_bf16 v[108:111], v[52:55], v[36:39], v[108:111]
    v_mfma_f32_16x16x32_bf16 v[112:115], v[52:55], v[40:43], v[112:115]
    v_mfma_f32_16x16x32_bf16 v[116:119], v[56:59], v[28:31], v[116:119]
    v_mfma_f32_16x16x32_bf16 v[120:123], v[56:59], v[32:35], v[120:123]
    v_mfma_f32_16x16x32_bf16 v[124:127], v[56:59], v[36:39], v[124:127]
    v_mfma_f32_16x16x32_bf16 v[128:131], v[56:59], v[40:43], v[128:131]
    v_mfma_f32_16x16x32_bf16 v[132:135], v[60:63], v[28:31], v[132:135]
    v_mfma_f32_16x16x32_bf16 v[136:139], v[60:63], v[32:35], v[136:139]
    v_mfma_f32_16x16x32_bf16 v[140:143], v[60:63], v[36:39], v[140:143]
    v_mfma_f32_16x16x32_bf16 v[144:147], v[60:63], v[40:43], v[144:147]
    v_mfma_f32_16x16x32_bf16 v[148:151], v[64:67], v[28:31], v[148:151]
    v_mfma_f32_16x16x32_bf16 v[152:155], v[64:67], v[32:35], v[152:155]
    v_mfma_f32_16x16x32_bf16 v[156:159], v[64:67], v[36:39], v[156:159]
    v_mfma_f32_16x16x32_bf16 v[160:163], v[64:67], v[40:43], v[160:163]
    s_nop 7
    s_nop 7
    v_and_b32 v3, 15, v2
    v_lshrrev_b32 v4, 4, v2
    s_lshl_b32 s3, s22, 8
    v_add_u32 v3, s3, v3
    s_lshl_b32 s3, s27, 6
    v_add_u32 v3, s3, v3
    s_mov_b32 s3, 9216
    v_mul_lo_u32 v3, v3, s3
    v_lshlrev_b32 v4, 3, v4
    v_add_u32 v3, v3, v4
    s_mul_i32 s3, s23, 288
    v_add_u32 v3, s3, v3
    s_mul_i32 s3, s28, 96
    v_add_u32 v3, s3, v3
    s_mov_b32 s23, 0xffff0000
    s_mov_b32 s24, 0xbfb8aa3b

    v_cvt_pk_bf16_f32 v12, v68, v69
    v_cvt_pk_bf16_f32 v13, v116, v117
    v_lshlrev_b32 v14, 16, v12
    v_and_b32 v15, s23, v12
    v_mul_f32 v16, s24, v14
    v_mul_f32 v17, s24, v15
    v_exp_f32 v16, v16
    v_exp_f32 v17, v17
    v_lshlrev_b32 v18, 16, v13
    v_add_f32 v16, 1.0, v16
    v_add_f32 v17, 1.0, v17
    v_rcp_f32 v16, v16
    v_rcp_f32 v17, v17
    v_and_b32 v19, s23, v13
    v_mul_f32 v14, v14, v16
    v_mul_f32 v15, v15, v17
    v_cvt_pk_bf16_f32 v12, v14, v15
    v_lshlrev_b32 v14, 16, v12
    v_and_b32 v15, s23, v12
    v_mul_f32 v14, v14, v18
    v_mul_f32 v15, v15, v19
    v_cvt_pk_bf16_f32 v22, v14, v15

    v_cvt_pk_bf16_f32 v12, v70, v71
    v_cvt_pk_bf16_f32 v13, v118, v119
    v_lshlrev_b32 v14, 16, v12
    v_and_b32 v15, s23, v12
    v_mul_f32 v16, s24, v14
    v_mul_f32 v17, s24, v15
    v_exp_f32 v16, v16
    v_exp_f32 v17, v17
    v_lshlrev_b32 v18, 16, v13
    v_add_f32 v16, 1.0, v16
    v_add_f32 v17, 1.0, v17
    v_rcp_f32 v16, v16
    v_rcp_f32 v17, v17
    v_and_b32 v19, s23, v13
    v_mul_f32 v14, v14, v16
    v_mul_f32 v15, v15, v17
    v_cvt_pk_bf16_f32 v12, v14, v15
    v_lshlrev_b32 v14, 16, v12
    v_and_b32 v15, s23, v12
    v_mul_f32 v14, v14, v18
    v_mul_f32 v15, v15, v19
    v_cvt_pk_bf16_f32 v23, v14, v15

    v_add_u32 v4, 0, v3
    buffer_store_dwordx2 v[22:23], v4, s[32:35], 0 offen offset:0

    v_cvt_pk_bf16_f32 v12, v72, v73
    v_cvt_pk_bf16_f32 v13, v120, v121
    v_lshlrev_b32 v14, 16, v12
    v_and_b32 v15, s23, v12
    v_mul_f32 v16, s24, v14
    v_mul_f32 v17, s24, v15
    v_exp_f32 v16, v16
    v_exp_f32 v17, v17
    v_lshlrev_b32 v18, 16, v13
    v_add_f32 v16, 1.0, v16
    v_add_f32 v17, 1.0, v17
    v_rcp_f32 v16, v16
    v_rcp_f32 v17, v17
    v_and_b32 v19, s23, v13
    v_mul_f32 v14, v14, v16
    v_mul_f32 v15, v15, v17
    v_cvt_pk_bf16_f32 v12, v14, v15
    v_lshlrev_b32 v14, 16, v12
    v_and_b32 v15, s23, v12
    v_mul_f32 v14, v14, v18
    v_mul_f32 v15, v15, v19
    v_cvt_pk_bf16_f32 v24, v14, v15

    v_cvt_pk_bf16_f32 v12, v74, v75
    v_cvt_pk_bf16_f32 v13, v122, v123
    v_lshlrev_b32 v14, 16, v12
    v_and_b32 v15, s23, v12
    v_mul_f32 v16, s24, v14
    v_mul_f32 v17, s24, v15
    v_exp_f32 v16, v16
    v_exp_f32 v17, v17
    v_lshlrev_b32 v18, 16, v13
    v_add_f32 v16, 1.0, v16
    v_add_f32 v17, 1.0, v17
    v_rcp_f32 v16, v16
    v_rcp_f32 v17, v17
    v_and_b32 v19, s23, v13
    v_mul_f32 v14, v14, v16
    v_mul_f32 v15, v15, v17
    v_cvt_pk_bf16_f32 v12, v14, v15
    v_lshlrev_b32 v14, 16, v12
    v_and_b32 v15, s23, v12
    v_mul_f32 v14, v14, v18
    v_mul_f32 v15, v15, v19
    v_cvt_pk_bf16_f32 v25, v14, v15

    v_add_u32 v4, 147456, v3
    buffer_store_dwordx2 v[24:25], v4, s[32:35], 0 offen offset:0

    v_cvt_pk_bf16_f32 v12, v76, v77
    v_cvt_pk_bf16_f32 v13, v124, v125
    v_lshlrev_b32 v14, 16, v12
    v_and_b32 v15, s23, v12
    v_mul_f32 v16, s24, v14
    v_mul_f32 v17, s24, v15
    v_exp_f32 v16, v16
    v_exp_f32 v17, v17
    v_lshlrev_b32 v18, 16, v13
    v_add_f32 v16, 1.0, v16
    v_add_f32 v17, 1.0, v17
    v_rcp_f32 v16, v16
    v_rcp_f32 v17, v17
    v_and_b32 v19, s23, v13
    v_mul_f32 v14, v14, v16
    v_mul_f32 v15, v15, v17
    v_cvt_pk_bf16_f32 v12, v14, v15
    v_lshlrev_b32 v14, 16, v12
    v_and_b32 v15, s23, v12
    v_mul_f32 v14, v14, v18
    v_mul_f32 v15, v15, v19
    v_cvt_pk_bf16_f32 v22, v14, v15

    v_cvt_pk_bf16_f32 v12, v78, v79
    v_cvt_pk_bf16_f32 v13, v126, v127
    v_lshlrev_b32 v14, 16, v12
    v_and_b32 v15, s23, v12
    v_mul_f32 v16, s24, v14
    v_mul_f32 v17, s24, v15
    v_exp_f32 v16, v16
    v_exp_f32 v17, v17
    v_lshlrev_b32 v18, 16, v13
    v_add_f32 v16, 1.0, v16
    v_add_f32 v17, 1.0, v17
    v_rcp_f32 v16, v16
    v_rcp_f32 v17, v17
    v_and_b32 v19, s23, v13
    v_mul_f32 v14, v14, v16
    v_mul_f32 v15, v15, v17
    v_cvt_pk_bf16_f32 v12, v14, v15
    v_lshlrev_b32 v14, 16, v12
    v_and_b32 v15, s23, v12
    v_mul_f32 v14, v14, v18
    v_mul_f32 v15, v15, v19
    v_cvt_pk_bf16_f32 v23, v14, v15

    v_add_u32 v4, 294912, v3
    buffer_store_dwordx2 v[22:23], v4, s[32:35], 0 offen offset:0

    v_cvt_pk_bf16_f32 v12, v80, v81
    v_cvt_pk_bf16_f32 v13, v128, v129
    v_lshlrev_b32 v14, 16, v12
    v_and_b32 v15, s23, v12
    v_mul_f32 v16, s24, v14
    v_mul_f32 v17, s24, v15
    v_exp_f32 v16, v16
    v_exp_f32 v17, v17
    v_lshlrev_b32 v18, 16, v13
    v_add_f32 v16, 1.0, v16
    v_add_f32 v17, 1.0, v17
    v_rcp_f32 v16, v16
    v_rcp_f32 v17, v17
    v_and_b32 v19, s23, v13
    v_mul_f32 v14, v14, v16
    v_mul_f32 v15, v15, v17
    v_cvt_pk_bf16_f32 v12, v14, v15
    v_lshlrev_b32 v14, 16, v12
    v_and_b32 v15, s23, v12
    v_mul_f32 v14, v14, v18
    v_mul_f32 v15, v15, v19
    v_cvt_pk_bf16_f32 v24, v14, v15

    v_cvt_pk_bf16_f32 v12, v82, v83
    v_cvt_pk_bf16_f32 v13, v130, v131
    v_lshlrev_b32 v14, 16, v12
    v_and_b32 v15, s23, v12
    v_mul_f32 v16, s24, v14
    v_mul_f32 v17, s24, v15
    v_exp_f32 v16, v16
    v_exp_f32 v17, v17
    v_lshlrev_b32 v18, 16, v13
    v_add_f32 v16, 1.0, v16
    v_add_f32 v17, 1.0, v17
    v_rcp_f32 v16, v16
    v_rcp_f32 v17, v17
    v_and_b32 v19, s23, v13
    v_mul_f32 v14, v14, v16
    v_mul_f32 v15, v15, v17
    v_cvt_pk_bf16_f32 v12, v14, v15
    v_lshlrev_b32 v14, 16, v12
    v_and_b32 v15, s23, v12
    v_mul_f32 v14, v14, v18
    v_mul_f32 v15, v15, v19
    v_cvt_pk_bf16_f32 v25, v14, v15

    v_add_u32 v4, 442368, v3
    buffer_store_dwordx2 v[24:25], v4, s[32:35], 0 offen offset:0

    v_cvt_pk_bf16_f32 v12, v84, v85
    v_cvt_pk_bf16_f32 v13, v132, v133
    v_lshlrev_b32 v14, 16, v12
    v_and_b32 v15, s23, v12
    v_mul_f32 v16, s24, v14
    v_mul_f32 v17, s24, v15
    v_exp_f32 v16, v16
    v_exp_f32 v17, v17
    v_lshlrev_b32 v18, 16, v13
    v_add_f32 v16, 1.0, v16
    v_add_f32 v17, 1.0, v17
    v_rcp_f32 v16, v16
    v_rcp_f32 v17, v17
    v_and_b32 v19, s23, v13
    v_mul_f32 v14, v14, v16
    v_mul_f32 v15, v15, v17
    v_cvt_pk_bf16_f32 v12, v14, v15
    v_lshlrev_b32 v14, 16, v12
    v_and_b32 v15, s23, v12
    v_mul_f32 v14, v14, v18
    v_mul_f32 v15, v15, v19
    v_cvt_pk_bf16_f32 v22, v14, v15

    v_cvt_pk_bf16_f32 v12, v86, v87
    v_cvt_pk_bf16_f32 v13, v134, v135
    v_lshlrev_b32 v14, 16, v12
    v_and_b32 v15, s23, v12
    v_mul_f32 v16, s24, v14
    v_mul_f32 v17, s24, v15
    v_exp_f32 v16, v16
    v_exp_f32 v17, v17
    v_lshlrev_b32 v18, 16, v13
    v_add_f32 v16, 1.0, v16
    v_add_f32 v17, 1.0, v17
    v_rcp_f32 v16, v16
    v_rcp_f32 v17, v17
    v_and_b32 v19, s23, v13
    v_mul_f32 v14, v14, v16
    v_mul_f32 v15, v15, v17
    v_cvt_pk_bf16_f32 v12, v14, v15
    v_lshlrev_b32 v14, 16, v12
    v_and_b32 v15, s23, v12
    v_mul_f32 v14, v14, v18
    v_mul_f32 v15, v15, v19
    v_cvt_pk_bf16_f32 v23, v14, v15

    v_add_u32 v4, 0, v3
    buffer_store_dwordx2 v[22:23], v4, s[32:35], 0 offen offset:32

    v_cvt_pk_bf16_f32 v12, v88, v89
    v_cvt_pk_bf16_f32 v13, v136, v137
    v_lshlrev_b32 v14, 16, v12
    v_and_b32 v15, s23, v12
    v_mul_f32 v16, s24, v14
    v_mul_f32 v17, s24, v15
    v_exp_f32 v16, v16
    v_exp_f32 v17, v17
    v_lshlrev_b32 v18, 16, v13
    v_add_f32 v16, 1.0, v16
    v_add_f32 v17, 1.0, v17
    v_rcp_f32 v16, v16
    v_rcp_f32 v17, v17
    v_and_b32 v19, s23, v13
    v_mul_f32 v14, v14, v16
    v_mul_f32 v15, v15, v17
    v_cvt_pk_bf16_f32 v12, v14, v15
    v_lshlrev_b32 v14, 16, v12
    v_and_b32 v15, s23, v12
    v_mul_f32 v14, v14, v18
    v_mul_f32 v15, v15, v19
    v_cvt_pk_bf16_f32 v24, v14, v15

    v_cvt_pk_bf16_f32 v12, v90, v91
    v_cvt_pk_bf16_f32 v13, v138, v139
    v_lshlrev_b32 v14, 16, v12
    v_and_b32 v15, s23, v12
    v_mul_f32 v16, s24, v14
    v_mul_f32 v17, s24, v15
    v_exp_f32 v16, v16
    v_exp_f32 v17, v17
    v_lshlrev_b32 v18, 16, v13
    v_add_f32 v16, 1.0, v16
    v_add_f32 v17, 1.0, v17
    v_rcp_f32 v16, v16
    v_rcp_f32 v17, v17
    v_and_b32 v19, s23, v13
    v_mul_f32 v14, v14, v16
    v_mul_f32 v15, v15, v17
    v_cvt_pk_bf16_f32 v12, v14, v15
    v_lshlrev_b32 v14, 16, v12
    v_and_b32 v15, s23, v12
    v_mul_f32 v14, v14, v18
    v_mul_f32 v15, v15, v19
    v_cvt_pk_bf16_f32 v25, v14, v15

    v_add_u32 v4, 147456, v3
    buffer_store_dwordx2 v[24:25], v4, s[32:35], 0 offen offset:32

    v_cvt_pk_bf16_f32 v12, v92, v93
    v_cvt_pk_bf16_f32 v13, v140, v141
    v_lshlrev_b32 v14, 16, v12
    v_and_b32 v15, s23, v12
    v_mul_f32 v16, s24, v14
    v_mul_f32 v17, s24, v15
    v_exp_f32 v16, v16
    v_exp_f32 v17, v17
    v_lshlrev_b32 v18, 16, v13
    v_add_f32 v16, 1.0, v16
    v_add_f32 v17, 1.0, v17
    v_rcp_f32 v16, v16
    v_rcp_f32 v17, v17
    v_and_b32 v19, s23, v13
    v_mul_f32 v14, v14, v16
    v_mul_f32 v15, v15, v17
    v_cvt_pk_bf16_f32 v12, v14, v15
    v_lshlrev_b32 v14, 16, v12
    v_and_b32 v15, s23, v12
    v_mul_f32 v14, v14, v18
    v_mul_f32 v15, v15, v19
    v_cvt_pk_bf16_f32 v22, v14, v15

    v_cvt_pk_bf16_f32 v12, v94, v95
    v_cvt_pk_bf16_f32 v13, v142, v143
    v_lshlrev_b32 v14, 16, v12
    v_and_b32 v15, s23, v12
    v_mul_f32 v16, s24, v14
    v_mul_f32 v17, s24, v15
    v_exp_f32 v16, v16
    v_exp_f32 v17, v17
    v_lshlrev_b32 v18, 16, v13
    v_add_f32 v16, 1.0, v16
    v_add_f32 v17, 1.0, v17
    v_rcp_f32 v16, v16
    v_rcp_f32 v17, v17
    v_and_b32 v19, s23, v13
    v_mul_f32 v14, v14, v16
    v_mul_f32 v15, v15, v17
    v_cvt_pk_bf16_f32 v12, v14, v15
    v_lshlrev_b32 v14, 16, v12
    v_and_b32 v15, s23, v12
    v_mul_f32 v14, v14, v18
    v_mul_f32 v15, v15, v19
    v_cvt_pk_bf16_f32 v23, v14, v15

    v_add_u32 v4, 294912, v3
    buffer_store_dwordx2 v[22:23], v4, s[32:35], 0 offen offset:32

    v_cvt_pk_bf16_f32 v12, v96, v97
    v_cvt_pk_bf16_f32 v13, v144, v145
    v_lshlrev_b32 v14, 16, v12
    v_and_b32 v15, s23, v12
    v_mul_f32 v16, s24, v14
    v_mul_f32 v17, s24, v15
    v_exp_f32 v16, v16
    v_exp_f32 v17, v17
    v_lshlrev_b32 v18, 16, v13
    v_add_f32 v16, 1.0, v16
    v_add_f32 v17, 1.0, v17
    v_rcp_f32 v16, v16
    v_rcp_f32 v17, v17
    v_and_b32 v19, s23, v13
    v_mul_f32 v14, v14, v16
    v_mul_f32 v15, v15, v17
    v_cvt_pk_bf16_f32 v12, v14, v15
    v_lshlrev_b32 v14, 16, v12
    v_and_b32 v15, s23, v12
    v_mul_f32 v14, v14, v18
    v_mul_f32 v15, v15, v19
    v_cvt_pk_bf16_f32 v24, v14, v15

    v_cvt_pk_bf16_f32 v12, v98, v99
    v_cvt_pk_bf16_f32 v13, v146, v147
    v_lshlrev_b32 v14, 16, v12
    v_and_b32 v15, s23, v12
    v_mul_f32 v16, s24, v14
    v_mul_f32 v17, s24, v15
    v_exp_f32 v16, v16
    v_exp_f32 v17, v17
    v_lshlrev_b32 v18, 16, v13
    v_add_f32 v16, 1.0, v16
    v_add_f32 v17, 1.0, v17
    v_rcp_f32 v16, v16
    v_rcp_f32 v17, v17
    v_and_b32 v19, s23, v13
    v_mul_f32 v14, v14, v16
    v_mul_f32 v15, v15, v17
    v_cvt_pk_bf16_f32 v12, v14, v15
    v_lshlrev_b32 v14, 16, v12
    v_and_b32 v15, s23, v12
    v_mul_f32 v14, v14, v18
    v_mul_f32 v15, v15, v19
    v_cvt_pk_bf16_f32 v25, v14, v15

    v_add_u32 v4, 442368, v3
    buffer_store_dwordx2 v[24:25], v4, s[32:35], 0 offen offset:32

    v_cvt_pk_bf16_f32 v12, v100, v101
    v_cvt_pk_bf16_f32 v13, v148, v149
    v_lshlrev_b32 v14, 16, v12
    v_and_b32 v15, s23, v12
    v_mul_f32 v16, s24, v14
    v_mul_f32 v17, s24, v15
    v_exp_f32 v16, v16
    v_exp_f32 v17, v17
    v_lshlrev_b32 v18, 16, v13
    v_add_f32 v16, 1.0, v16
    v_add_f32 v17, 1.0, v17
    v_rcp_f32 v16, v16
    v_rcp_f32 v17, v17
    v_and_b32 v19, s23, v13
    v_mul_f32 v14, v14, v16
    v_mul_f32 v15, v15, v17
    v_cvt_pk_bf16_f32 v12, v14, v15
    v_lshlrev_b32 v14, 16, v12
    v_and_b32 v15, s23, v12
    v_mul_f32 v14, v14, v18
    v_mul_f32 v15, v15, v19
    v_cvt_pk_bf16_f32 v22, v14, v15

    v_cvt_pk_bf16_f32 v12, v102, v103
    v_cvt_pk_bf16_f32 v13, v150, v151
    v_lshlrev_b32 v14, 16, v12
    v_and_b32 v15, s23, v12
    v_mul_f32 v16, s24, v14
    v_mul_f32 v17, s24, v15
    v_exp_f32 v16, v16
    v_exp_f32 v17, v17
    v_lshlrev_b32 v18, 16, v13
    v_add_f32 v16, 1.0, v16
    v_add_f32 v17, 1.0, v17
    v_rcp_f32 v16, v16
    v_rcp_f32 v17, v17
    v_and_b32 v19, s23, v13
    v_mul_f32 v14, v14, v16
    v_mul_f32 v15, v15, v17
    v_cvt_pk_bf16_f32 v12, v14, v15
    v_lshlrev_b32 v14, 16, v12
    v_and_b32 v15, s23, v12
    v_mul_f32 v14, v14, v18
    v_mul_f32 v15, v15, v19
    v_cvt_pk_bf16_f32 v23, v14, v15

    v_add_u32 v4, 0, v3
    buffer_store_dwordx2 v[22:23], v4, s[32:35], 0 offen offset:64

    v_cvt_pk_bf16_f32 v12, v104, v105
    v_cvt_pk_bf16_f32 v13, v152, v153
    v_lshlrev_b32 v14, 16, v12
    v_and_b32 v15, s23, v12
    v_mul_f32 v16, s24, v14
    v_mul_f32 v17, s24, v15
    v_exp_f32 v16, v16
    v_exp_f32 v17, v17
    v_lshlrev_b32 v18, 16, v13
    v_add_f32 v16, 1.0, v16
    v_add_f32 v17, 1.0, v17
    v_rcp_f32 v16, v16
    v_rcp_f32 v17, v17
    v_and_b32 v19, s23, v13
    v_mul_f32 v14, v14, v16
    v_mul_f32 v15, v15, v17
    v_cvt_pk_bf16_f32 v12, v14, v15
    v_lshlrev_b32 v14, 16, v12
    v_and_b32 v15, s23, v12
    v_mul_f32 v14, v14, v18
    v_mul_f32 v15, v15, v19
    v_cvt_pk_bf16_f32 v24, v14, v15

    v_cvt_pk_bf16_f32 v12, v106, v107
    v_cvt_pk_bf16_f32 v13, v154, v155
    v_lshlrev_b32 v14, 16, v12
    v_and_b32 v15, s23, v12
    v_mul_f32 v16, s24, v14
    v_mul_f32 v17, s24, v15
    v_exp_f32 v16, v16
    v_exp_f32 v17, v17
    v_lshlrev_b32 v18, 16, v13
    v_add_f32 v16, 1.0, v16
    v_add_f32 v17, 1.0, v17
    v_rcp_f32 v16, v16
    v_rcp_f32 v17, v17
    v_and_b32 v19, s23, v13
    v_mul_f32 v14, v14, v16
    v_mul_f32 v15, v15, v17
    v_cvt_pk_bf16_f32 v12, v14, v15
    v_lshlrev_b32 v14, 16, v12
    v_and_b32 v15, s23, v12
    v_mul_f32 v14, v14, v18
    v_mul_f32 v15, v15, v19
    v_cvt_pk_bf16_f32 v25, v14, v15

    v_add_u32 v4, 147456, v3
    buffer_store_dwordx2 v[24:25], v4, s[32:35], 0 offen offset:64

    v_cvt_pk_bf16_f32 v12, v108, v109
    v_cvt_pk_bf16_f32 v13, v156, v157
    v_lshlrev_b32 v14, 16, v12
    v_and_b32 v15, s23, v12
    v_mul_f32 v16, s24, v14
    v_mul_f32 v17, s24, v15
    v_exp_f32 v16, v16
    v_exp_f32 v17, v17
    v_lshlrev_b32 v18, 16, v13
    v_add_f32 v16, 1.0, v16
    v_add_f32 v17, 1.0, v17
    v_rcp_f32 v16, v16
    v_rcp_f32 v17, v17
    v_and_b32 v19, s23, v13
    v_mul_f32 v14, v14, v16
    v_mul_f32 v15, v15, v17
    v_cvt_pk_bf16_f32 v12, v14, v15
    v_lshlrev_b32 v14, 16, v12
    v_and_b32 v15, s23, v12
    v_mul_f32 v14, v14, v18
    v_mul_f32 v15, v15, v19
    v_cvt_pk_bf16_f32 v22, v14, v15

    v_cvt_pk_bf16_f32 v12, v110, v111
    v_cvt_pk_bf16_f32 v13, v158, v159
    v_lshlrev_b32 v14, 16, v12
    v_and_b32 v15, s23, v12
    v_mul_f32 v16, s24, v14
    v_mul_f32 v17, s24, v15
    v_exp_f32 v16, v16
    v_exp_f32 v17, v17
    v_lshlrev_b32 v18, 16, v13
    v_add_f32 v16, 1.0, v16
    v_add_f32 v17, 1.0, v17
    v_rcp_f32 v16, v16
    v_rcp_f32 v17, v17
    v_and_b32 v19, s23, v13
    v_mul_f32 v14, v14, v16
    v_mul_f32 v15, v15, v17
    v_cvt_pk_bf16_f32 v12, v14, v15
    v_lshlrev_b32 v14, 16, v12
    v_and_b32 v15, s23, v12
    v_mul_f32 v14, v14, v18
    v_mul_f32 v15, v15, v19
    v_cvt_pk_bf16_f32 v23, v14, v15

    v_add_u32 v4, 294912, v3
    buffer_store_dwordx2 v[22:23], v4, s[32:35], 0 offen offset:64

    v_cvt_pk_bf16_f32 v12, v112, v113
    v_cvt_pk_bf16_f32 v13, v160, v161
    v_lshlrev_b32 v14, 16, v12
    v_and_b32 v15, s23, v12
    v_mul_f32 v16, s24, v14
    v_mul_f32 v17, s24, v15
    v_exp_f32 v16, v16
    v_exp_f32 v17, v17
    v_lshlrev_b32 v18, 16, v13
    v_add_f32 v16, 1.0, v16
    v_add_f32 v17, 1.0, v17
    v_rcp_f32 v16, v16
    v_rcp_f32 v17, v17
    v_and_b32 v19, s23, v13
    v_mul_f32 v14, v14, v16
    v_mul_f32 v15, v15, v17
    v_cvt_pk_bf16_f32 v12, v14, v15
    v_lshlrev_b32 v14, 16, v12
    v_and_b32 v15, s23, v12
    v_mul_f32 v14, v14, v18
    v_mul_f32 v15, v15, v19
    v_cvt_pk_bf16_f32 v24, v14, v15

    v_cvt_pk_bf16_f32 v12, v114, v115
    v_cvt_pk_bf16_f32 v13, v162, v163
    v_lshlrev_b32 v14, 16, v12
    v_and_b32 v15, s23, v12
    v_mul_f32 v16, s24, v14
    v_mul_f32 v17, s24, v15
    v_exp_f32 v16, v16
    v_exp_f32 v17, v17
    v_lshlrev_b32 v18, 16, v13
    v_add_f32 v16, 1.0, v16
    v_add_f32 v17, 1.0, v17
    v_rcp_f32 v16, v16
    v_rcp_f32 v17, v17
    v_and_b32 v19, s23, v13
    v_mul_f32 v14, v14, v16
    v_mul_f32 v15, v15, v17
    v_cvt_pk_bf16_f32 v12, v14, v15
    v_lshlrev_b32 v14, 16, v12
    v_and_b32 v15, s23, v12
    v_mul_f32 v14, v14, v18
    v_mul_f32 v15, v15, v19
    v_cvt_pk_bf16_f32 v25, v14, v15

    v_add_u32 v4, 442368, v3
    buffer_store_dwordx2 v[24:25], v4, s[32:35], 0 offen offset:64

gemm1_done:
    s_endpgm
.globl gemm2_kernel
.p2align 8
.type gemm2_kernel,@function
gemm2_kernel:
    s_cmp_ge_u32 s2, 256
    s_cbranch_scc1 gemm2_done
    s_load_dwordx2 s[4:5], s[0:1], 96
    s_load_dwordx2 s[6:7], s[0:1], 72
    s_load_dwordx2 s[8:9], s[0:1], 64
    s_and_b32 s20, s2, 7
    s_lshr_b32 s21, s2, 3

    s_and_b32 s22, s21, 7
    s_and_b32 s3, s20, 1
    s_lshl_b32 s3, s3, 3
    s_add_u32 s22, s22, s3
    s_lshr_b32 s23, s21, 3
    s_lshr_b32 s25, s20, 1
    s_mul_i32 s24, s25, 1152

    v_lshrrev_b32 v1, 6, v0
    v_and_b32 v2, 63, v0
    s_nop 0
    v_readfirstlane_b32 s26, v1
    s_waitcnt lgkmcnt(0)

    s_add_u32 s10, s4, 16777216
    s_addc_u32 s11, s5, 0
    s_add_u32 s32, s4, 50331648
    s_addc_u32 s33, s5, 0
    s_mov_b32 s34, 18874368
    s_mov_b32 s35, 0x00020000
    s_mov_b32 s90, 18874368
    s_mov_b32 s91, 5308416
    s_mov_b32 s92, 73728
    s_add_u32 s27, s26, 0
    s_min_u32 s27, s27, 33
    s_and_b32 s3, s27, 7
    s_lshl_b32 s3, s3, 4
    v_lshrrev_b32 v44, 2, v2
    v_add_u32 v44, s3, v44
    v_lshrrev_b32 v45, 2, v44
    v_sub_u32 v45, 0, v45
    v_xor_b32 v45, v45, v2
    v_and_b32 v45, 3, v45
    v_lshlrev_b32 v45, 4, v45
    s_mul_i32 s3, s22, 128
    v_add_u32 v44, s3, v44
    s_mov_b32 s3, 9216
    v_mul_lo_u32 v44, v44, s3
    v_add_u32 v44, v44, v45
    s_lshr_b32 s3, s27, 3
    s_lshl_b32 s3, s3, 6
    s_mul_i32 s3, s3, 1
    v_add_u32 v44, s3, v44
    s_sub_u32 s28, s27, 16
    s_cmp_ge_i32 s28, 9
    s_cselect_b32 s29, 9, 0
    s_sub_u32 s28, s28, s29
    s_lshl_b32 s3, s28, 6
    v_add_u32 v45, s3, v2
    v_mul_u32_u24 v46, 3641, v45
    v_lshrrev_b32 v46, 16, v46
    v_mul_u32_u24 v47, 18, v46
    v_sub_u32 v47, v45, v47
    v_bfe_u32 v48, v46, 3, 1
    v_lshlrev_b32 v48, 2, v48
    v_xor_b32 v46, v46, v48
    s_mov_b32 s3, 1152
    v_mul_lo_u32 v46, v46, s3
    v_lshlrev_b32 v47, 4, v47
    v_add_u32 v46, v46, v47
    s_mul_i32 s3, s23, 288
    v_add_u32 v46, s3, v46
    s_cmp_ge_u32 s27, 25
    s_cselect_b32 s3, 36864, 0
    v_add_u32 v46, s3, v46
    s_cselect_b32 s64, s6, s6
    s_cselect_b32 s65, s7, s7
    s_lshl_b32 s3, s24, 1
    s_mul_i32 s29, s24, 1152
    s_cmp_lt_u32 s27, 16
    s_cselect_b64 s[36:37], -1, 0
    s_cselect_b32 s64, s10, s64
    s_cselect_b32 s65, s11, s65
    s_cselect_b32 s66, s90, s91
    s_mov_b32 s67, 0x00020000
    s_cselect_b32 s76, s3, s29
    s_cselect_b32 s80, 128, s92
    s_lshl_b32 s84, s27, 10
    s_nop 1
    v_cndmask_b32 v3, v46, v44, s[36:37]

    s_add_u32 s27, s26, 12
    s_min_u32 s27, s27, 33
    s_and_b32 s3, s27, 7
    s_lshl_b32 s3, s3, 4
    v_lshrrev_b32 v44, 2, v2
    v_add_u32 v44, s3, v44
    v_lshrrev_b32 v45, 2, v44
    v_sub_u32 v45, 0, v45
    v_xor_b32 v45, v45, v2
    v_and_b32 v45, 3, v45
    v_lshlrev_b32 v45, 4, v45
    s_mul_i32 s3, s22, 128
    v_add_u32 v44, s3, v44
    s_mov_b32 s3, 9216
    v_mul_lo_u32 v44, v44, s3
    v_add_u32 v44, v44, v45
    s_lshr_b32 s3, s27, 3
    s_lshl_b32 s3, s3, 6
    s_mul_i32 s3, s3, 1
    v_add_u32 v44, s3, v44
    s_sub_u32 s28, s27, 16
    s_cmp_ge_i32 s28, 9
    s_cselect_b32 s29, 9, 0
    s_sub_u32 s28, s28, s29
    s_lshl_b32 s3, s28, 6
    v_add_u32 v45, s3, v2
    v_mul_u32_u24 v46, 3641, v45
    v_lshrrev_b32 v46, 16, v46
    v_mul_u32_u24 v47, 18, v46
    v_sub_u32 v47, v45, v47
    v_bfe_u32 v48, v46, 3, 1
    v_lshlrev_b32 v48, 2, v48
    v_xor_b32 v46, v46, v48
    s_mov_b32 s3, 1152
    v_mul_lo_u32 v46, v46, s3
    v_lshlrev_b32 v47, 4, v47
    v_add_u32 v46, v46, v47
    s_mul_i32 s3, s23, 288
    v_add_u32 v46, s3, v46
    s_cmp_ge_u32 s27, 25
    s_cselect_b32 s3, 36864, 0
    v_add_u32 v46, s3, v46
    s_cselect_b32 s68, s6, s6
    s_cselect_b32 s69, s7, s7
    s_lshl_b32 s3, s24, 1
    s_mul_i32 s29, s24, 1152
    s_cmp_lt_u32 s27, 16
    s_cselect_b64 s[36:37], -1, 0
    s_cselect_b32 s68, s10, s68
    s_cselect_b32 s69, s11, s69
    s_cselect_b32 s70, s90, s91
    s_mov_b32 s71, 0x00020000
    s_cselect_b32 s77, s3, s29
    s_cselect_b32 s81, 128, s92
    s_lshl_b32 s85, s27, 10
    s_nop 1
    v_cndmask_b32 v4, v46, v44, s[36:37]

    s_add_u32 s27, s26, 24
    s_min_u32 s27, s27, 33
    s_and_b32 s3, s27, 7
    s_lshl_b32 s3, s3, 4
    v_lshrrev_b32 v44, 2, v2
    v_add_u32 v44, s3, v44
    v_lshrrev_b32 v45, 2, v44
    v_sub_u32 v45, 0, v45
    v_xor_b32 v45, v45, v2
    v_and_b32 v45, 3, v45
    v_lshlrev_b32 v45, 4, v45
    s_mul_i32 s3, s22, 128
    v_add_u32 v44, s3, v44
    s_mov_b32 s3, 9216
    v_mul_lo_u32 v44, v44, s3
    v_add_u32 v44, v44, v45
    s_lshr_b32 s3, s27, 3
    s_lshl_b32 s3, s3, 6
    s_mul_i32 s3, s3, 1
    v_add_u32 v44, s3, v44
    s_sub_u32 s28, s27, 16
    s_cmp_ge_i32 s28, 9
    s_cselect_b32 s29, 9, 0
    s_sub_u32 s28, s28, s29
    s_lshl_b32 s3, s28, 6
    v_add_u32 v45, s3, v2
    v_mul_u32_u24 v46, 3641, v45
    v_lshrrev_b32 v46, 16, v46
    v_mul_u32_u24 v47, 18, v46
    v_sub_u32 v47, v45, v47
    v_bfe_u32 v48, v46, 3, 1
    v_lshlrev_b32 v48, 2, v48
    v_xor_b32 v46, v46, v48
    s_mov_b32 s3, 1152
    v_mul_lo_u32 v46, v46, s3
    v_lshlrev_b32 v47, 4, v47
    v_add_u32 v46, v46, v47
    s_mul_i32 s3, s23, 288
    v_add_u32 v46, s3, v46
    s_cmp_ge_u32 s27, 25
    s_cselect_b32 s3, 36864, 0
    v_add_u32 v46, s3, v46
    s_cselect_b32 s72, s6, s6
    s_cselect_b32 s73, s7, s7
    s_lshl_b32 s3, s24, 1
    s_mul_i32 s29, s24, 1152
    s_cmp_lt_u32 s27, 16
    s_cselect_b64 s[36:37], -1, 0
    s_cselect_b32 s72, s10, s72
    s_cselect_b32 s73, s11, s73
    s_cselect_b32 s74, s90, s91
    s_mov_b32 s75, 0x00020000
    s_cselect_b32 s78, s3, s29
    s_cselect_b32 s82, 128, s92
    s_lshl_b32 s86, s27, 10
    s_nop 1
    v_cndmask_b32 v5, v46, v44, s[36:37]

    s_add_u32 m0, s84, 0
    s_nop 0
    buffer_load_dwordx4 v3, s[64:67], s76 offen lds
    s_add_u32 s76, s76, s80

    s_add_u32 m0, s85, 0
    s_nop 0
    buffer_load_dwordx4 v4, s[68:71], s77 offen lds
    s_add_u32 s77, s77, s81

    s_add_u32 m0, s86, 0
    s_nop 0
    buffer_load_dwordx4 v5, s[72:75], s78 offen lds
    s_add_u32 s78, s78, s82

    s_add_u32 m0, s84, 34816
    s_nop 0
    buffer_load_dwordx4 v3, s[64:67], s76 offen lds
    s_add_u32 s76, s76, s80

    s_add_u32 m0, s85, 34816
    s_nop 0
    buffer_load_dwordx4 v4, s[68:71], s77 offen lds
    s_add_u32 s77, s77, s81

    s_add_u32 m0, s86, 34816
    s_nop 0
    buffer_load_dwordx4 v5, s[72:75], s78 offen lds
    s_add_u32 s78, s78, s82

    s_add_u32 m0, s84, 69632
    s_nop 0
    buffer_load_dwordx4 v3, s[64:67], s76 offen lds
    s_add_u32 s76, s76, s80

    s_add_u32 m0, s85, 69632
    s_nop 0
    buffer_load_dwordx4 v4, s[68:71], s77 offen lds
    s_add_u32 s77, s77, s81

    s_add_u32 m0, s86, 69632
    s_nop 0
    buffer_load_dwordx4 v5, s[72:75], s78 offen lds
    s_add_u32 s78, s78, s82

    s_cmp_ge_u32 s26, 6
    s_cselect_b32 s39, 1, 0
    s_mul_i32 s3, s39, 6
    s_sub_u32 s93, s26, s3
    s_cmp_ge_u32 s93, 2
    s_cselect_b32 s28, 1, 0
    s_cmp_ge_u32 s93, 4
    s_cselect_b32 s28, 2, s28
    s_mul_i32 s3, s28, 2
    s_sub_u32 s27, s93, s3
    v_and_b32 v44, 15, v2
    v_lshrrev_b32 v45, 4, v2
    v_lshrrev_b32 v46, 2, v44
    v_sub_u32 v46, 0, v46
    v_xor_b32 v46, v46, v45
    v_and_b32 v46, 3, v46
    v_lshlrev_b32 v46, 4, v46
    v_lshlrev_b32 v47, 6, v44
    v_add_u32 v46, v46, v47
    s_lshl_b32 s3, s27, 12
    v_add_u32 v6, s3, v46
    s_lshl_b32 s3, s39, 13
    v_add_u32 v6, s3, v6
    v_bfe_u32 v46, v2, 2, 2
    v_lshl_add_u32 v46, v45, 3, v46
    v_and_b32 v47, 1, v45
    v_lshlrev_b32 v47, 2, v47
    v_add_u32 v48, v46, v47
    v_xor_b32 v47, 4, v47
    v_add_u32 v49, v46, v47
    v_mul_u32_u24 v48, 288, v48
    v_mul_u32_u24 v49, 288, v49
    v_and_b32 v47, 3, v2
    v_lshlrev_b32 v47, 3, v47
    s_mul_i32 s3, s28, 96
    s_add_u32 s3, s3, 16384
    s_mul_i32 s29, s39, 9216
    s_add_u32 s3, s3, s29
    v_add3_u32 v7, v48, v47, s3
    v_add3_u32 v8, v49, v47, s3
    v_add_u32 v9, 69632, v6
    v_add_u32 v10, 69632, v7
    v_add_u32 v11, 69632, v8

    v_mov_b32 v68, 0
    v_mov_b32 v69, 0
    v_mov_b32 v70, 0
    v_mov_b32 v71, 0
    v_mov_b32 v72, 0
    v_mov_b32 v73, 0
    v_mov_b32 v74, 0
    v_mov_b32 v75, 0
    v_mov_b32 v76, 0
    v_mov_b32 v77, 0
    v_mov_b32 v78, 0
    v_mov_b32 v79, 0
    v_mov_b32 v80, 0
    v_mov_b32 v81, 0
    v_mov_b32 v82, 0
    v_mov_b32 v83, 0
    v_mov_b32 v84, 0
    v_mov_b32 v85, 0
    v_mov_b32 v86, 0
    v_mov_b32 v87, 0
    v_mov_b32 v88, 0
    v_mov_b32 v89, 0
    v_mov_b32 v90, 0
    v_mov_b32 v91, 0
    v_mov_b32 v92, 0
    v_mov_b32 v93, 0
    v_mov_b32 v94, 0
    v_mov_b32 v95, 0
    v_mov_b32 v96, 0
    v_mov_b32 v97, 0
    v_mov_b32 v98, 0
    v_mov_b32 v99, 0
    v_mov_b32 v100, 0
    v_mov_b32 v101, 0
    v_mov_b32 v102, 0
    v_mov_b32 v103, 0
    v_mov_b32 v104, 0
    v_mov_b32 v105, 0
    v_mov_b32 v106, 0
    v_mov_b32 v107, 0
    v_mov_b32 v108, 0
    v_mov_b32 v109, 0
    v_mov_b32 v110, 0
    v_mov_b32 v111, 0
    v_mov_b32 v112, 0
    v_mov_b32 v113, 0
    v_mov_b32 v114, 0
    v_mov_b32 v115, 0
    s_waitcnt vmcnt(6)
    s_barrier
    ds_read_b64_tr_b16 v[44:45], v7 offset:0
    ds_read_b64_tr_b16 v[46:47], v8 offset:0

    ds_read_b128 v[12:15], v6 offset:0
    ds_read_b128 v[16:19], v6 offset:1024
    ds_read_b128 v[20:23], v6 offset:2048
    ds_read_b128 v[24:27], v6 offset:3072
    ds_read_b64_tr_b16 v[48:49], v7 offset:32
    ds_read_b64_tr_b16 v[50:51], v8 offset:32

    ds_read_b64_tr_b16 v[52:53], v7 offset:64
    ds_read_b64_tr_b16 v[54:55], v8 offset:64

    s_mov_b32 s38, 3
g2_loop:
    s_waitcnt vmcnt(3)
    s_barrier
    s_waitcnt lgkmcnt(4)
    v_mfma_f32_16x16x32_bf16 v[68:71], v[44:47], v[12:15], v[68:71]
    v_mfma_f32_16x16x32_bf16 v[72:75], v[44:47], v[16:19], v[72:75]
    v_mfma_f32_16x16x32_bf16 v[76:79], v[44:47], v[20:23], v[76:79]
    v_mfma_f32_16x16x32_bf16 v[80:83], v[44:47], v[24:27], v[80:83]
    ds_read_b64_tr_b16 v[44:45], v7 offset:34816
    ds_read_b64_tr_b16 v[46:47], v8 offset:34816

    ds_read_b128 v[28:31], v6 offset:34816
    ds_read_b128 v[32:35], v6 offset:35840
    ds_read_b128 v[36:39], v6 offset:36864
    ds_read_b128 v[40:43], v6 offset:37888
    s_add_u32 m0, s84, 104448
    s_nop 0
    buffer_load_dwordx4 v3, s[64:67], s76 offen lds
    s_add_u32 s76, s76, s80

    s_waitcnt lgkmcnt(8)
    v_mfma_f32_16x16x32_bf16 v[84:87], v[48:51], v[12:15], v[84:87]
    v_mfma_f32_16x16x32_bf16 v[88:91], v[48:51], v[16:19], v[88:91]
    v_mfma_f32_16x16x32_bf16 v[92:95], v[48:51], v[20:23], v[92:95]
    v_mfma_f32_16x16x32_bf16 v[96:99], v[48:51], v[24:27], v[96:99]
    ds_read_b64_tr_b16 v[48:49], v7 offset:34848
    ds_read_b64_tr_b16 v[50:51], v8 offset:34848

    s_add_u32 m0, s85, 104448
    s_nop 0
    buffer_load_dwordx4 v4, s[68:71], s77 offen lds
    s_add_u32 s77, s77, s81

    s_waitcnt lgkmcnt(8)
    v_mfma_f32_16x16x32_bf16 v[100:103], v[52:55], v[12:15], v[100:103]
    v_mfma_f32_16x16x32_bf16 v[104:107], v[52:55], v[16:19], v[104:107]
    v_mfma_f32_16x16x32_bf16 v[108:111], v[52:55], v[20:23], v[108:111]
    v_mfma_f32_16x16x32_bf16 v[112:115], v[52:55], v[24:27], v[112:115]
    ds_read_b64_tr_b16 v[52:53], v7 offset:34880
    ds_read_b64_tr_b16 v[54:55], v8 offset:34880

    s_add_u32 m0, s86, 104448
    s_nop 0
    buffer_load_dwordx4 v5, s[72:75], s78 offen lds
    s_add_u32 s78, s78, s82

    s_waitcnt vmcnt(3)
    s_barrier
    s_waitcnt lgkmcnt(4)
    v_mfma_f32_16x16x32_bf16 v[68:71], v[44:47], v[28:31], v[68:71]
    v_mfma_f32_16x16x32_bf16 v[72:75], v[44:47], v[32:35], v[72:75]
    v_mfma_f32_16x16x32_bf16 v[76:79], v[44:47], v[36:39], v[76:79]
    v_mfma_f32_16x16x32_bf16 v[80:83], v[44:47], v[40:43], v[80:83]
    ds_read_b64_tr_b16 v[44:45], v10 offset:0
    ds_read_b64_tr_b16 v[46:47], v11 offset:0

    ds_read_b128 v[12:15], v9 offset:0
    ds_read_b128 v[16:19], v9 offset:1024
    ds_read_b128 v[20:23], v9 offset:2048
    ds_read_b128 v[24:27], v9 offset:3072
    s_add_u32 m0, s84, 0
    s_nop 0
    buffer_load_dwordx4 v3, s[64:67], s76 offen lds
    s_add_u32 s76, s76, s80

    s_waitcnt lgkmcnt(8)
    v_mfma_f32_16x16x32_bf16 v[84:87], v[48:51], v[28:31], v[84:87]
    v_mfma_f32_16x16x32_bf16 v[88:91], v[48:51], v[32:35], v[88:91]
    v_mfma_f32_16x16x32_bf16 v[92:95], v[48:51], v[36:39], v[92:95]
    v_mfma_f32_16x16x32_bf16 v[96:99], v[48:51], v[40:43], v[96:99]
    ds_read_b64_tr_b16 v[48:49], v10 offset:32
    ds_read_b64_tr_b16 v[50:51], v11 offset:32

    s_add_u32 m0, s85, 0
    s_nop 0
    buffer_load_dwordx4 v4, s[68:71], s77 offen lds
    s_add_u32 s77, s77, s81

    s_waitcnt lgkmcnt(8)
    v_mfma_f32_16x16x32_bf16 v[100:103], v[52:55], v[28:31], v[100:103]
    v_mfma_f32_16x16x32_bf16 v[104:107], v[52:55], v[32:35], v[104:107]
    v_mfma_f32_16x16x32_bf16 v[108:111], v[52:55], v[36:39], v[108:111]
    v_mfma_f32_16x16x32_bf16 v[112:115], v[52:55], v[40:43], v[112:115]
    ds_read_b64_tr_b16 v[52:53], v10 offset:64
    ds_read_b64_tr_b16 v[54:55], v11 offset:64

    s_add_u32 m0, s86, 0
    s_nop 0
    buffer_load_dwordx4 v5, s[72:75], s78 offen lds
    s_add_u32 s78, s78, s82

    s_waitcnt vmcnt(3)
    s_barrier
    s_waitcnt lgkmcnt(4)
    v_mfma_f32_16x16x32_bf16 v[68:71], v[44:47], v[12:15], v[68:71]
    v_mfma_f32_16x16x32_bf16 v[72:75], v[44:47], v[16:19], v[72:75]
    v_mfma_f32_16x16x32_bf16 v[76:79], v[44:47], v[20:23], v[76:79]
    v_mfma_f32_16x16x32_bf16 v[80:83], v[44:47], v[24:27], v[80:83]
    ds_read_b64_tr_b16 v[44:45], v10 offset:34816
    ds_read_b64_tr_b16 v[46:47], v11 offset:34816

    ds_read_b128 v[28:31], v9 offset:34816
    ds_read_b128 v[32:35], v9 offset:35840
    ds_read_b128 v[36:39], v9 offset:36864
    ds_read_b128 v[40:43], v9 offset:37888
    s_add_u32 m0, s84, 34816
    s_nop 0
    buffer_load_dwordx4 v3, s[64:67], s76 offen lds
    s_add_u32 s76, s76, s80

    s_waitcnt lgkmcnt(8)
    v_mfma_f32_16x16x32_bf16 v[84:87], v[48:51], v[12:15], v[84:87]
    v_mfma_f32_16x16x32_bf16 v[88:91], v[48:51], v[16:19], v[88:91]
    v_mfma_f32_16x16x32_bf16 v[92:95], v[48:51], v[20:23], v[92:95]
    v_mfma_f32_16x16x32_bf16 v[96:99], v[48:51], v[24:27], v[96:99]
    ds_read_b64_tr_b16 v[48:49], v10 offset:34848
    ds_read_b64_tr_b16 v[50:51], v11 offset:34848

    s_add_u32 m0, s85, 34816
    s_nop 0
    buffer_load_dwordx4 v4, s[68:71], s77 offen lds
    s_add_u32 s77, s77, s81

    s_waitcnt lgkmcnt(8)
    v_mfma_f32_16x16x32_bf16 v[100:103], v[52:55], v[12:15], v[100:103]
    v_mfma_f32_16x16x32_bf16 v[104:107], v[52:55], v[16:19], v[104:107]
    v_mfma_f32_16x16x32_bf16 v[108:111], v[52:55], v[20:23], v[108:111]
    v_mfma_f32_16x16x32_bf16 v[112:115], v[52:55], v[24:27], v[112:115]
    ds_read_b64_tr_b16 v[52:53], v10 offset:34880
    ds_read_b64_tr_b16 v[54:55], v11 offset:34880

    s_add_u32 m0, s86, 34816
    s_nop 0
    buffer_load_dwordx4 v5, s[72:75], s78 offen lds
    s_add_u32 s78, s78, s82

    s_waitcnt vmcnt(3)
    s_barrier
    s_waitcnt lgkmcnt(4)
    v_mfma_f32_16x16x32_bf16 v[68:71], v[44:47], v[28:31], v[68:71]
    v_mfma_f32_16x16x32_bf16 v[72:75], v[44:47], v[32:35], v[72:75]
    v_mfma_f32_16x16x32_bf16 v[76:79], v[44:47], v[36:39], v[76:79]
    v_mfma_f32_16x16x32_bf16 v[80:83], v[44:47], v[40:43], v[80:83]
    ds_read_b64_tr_b16 v[44:45], v7 offset:0
    ds_read_b64_tr_b16 v[46:47], v8 offset:0

    ds_read_b128 v[12:15], v6 offset:0
    ds_read_b128 v[16:19], v6 offset:1024
    ds_read_b128 v[20:23], v6 offset:2048
    ds_read_b128 v[24:27], v6 offset:3072
    s_add_u32 m0, s84, 69632
    s_nop 0
    buffer_load_dwordx4 v3, s[64:67], s76 offen lds
    s_add_u32 s76, s76, s80

    s_waitcnt lgkmcnt(8)
    v_mfma_f32_16x16x32_bf16 v[84:87], v[48:51], v[28:31], v[84:87]
    v_mfma_f32_16x16x32_bf16 v[88:91], v[48:51], v[32:35], v[88:91]
    v_mfma_f32_16x16x32_bf16 v[92:95], v[48:51], v[36:39], v[92:95]
    v_mfma_f32_16x16x32_bf16 v[96:99], v[48:51], v[40:43], v[96:99]
    ds_read_b64_tr_b16 v[48:49], v7 offset:32
    ds_read_b64_tr_b16 v[50:51], v8 offset:32

    s_add_u32 m0, s85, 69632
    s_nop 0
    buffer_load_dwordx4 v4, s[68:71], s77 offen lds
    s_add_u32 s77, s77, s81

    s_waitcnt lgkmcnt(8)
    v_mfma_f32_16x16x32_bf16 v[100:103], v[52:55], v[28:31], v[100:103]
    v_mfma_f32_16x16x32_bf16 v[104:107], v[52:55], v[32:35], v[104:107]
    v_mfma_f32_16x16x32_bf16 v[108:111], v[52:55], v[36:39], v[108:111]
    v_mfma_f32_16x16x32_bf16 v[112:115], v[52:55], v[40:43], v[112:115]
    ds_read_b64_tr_b16 v[52:53], v7 offset:64
    ds_read_b64_tr_b16 v[54:55], v8 offset:64

    s_add_u32 m0, s86, 69632
    s_nop 0
    buffer_load_dwordx4 v5, s[72:75], s78 offen lds
    s_add_u32 s78, s78, s82

    s_sub_u32 s38, s38, 1
    s_cmp_lg_u32 s38, 0
    s_cbranch_scc1 g2_loop
    s_waitcnt vmcnt(3)
    s_barrier
    s_waitcnt lgkmcnt(4)
    v_mfma_f32_16x16x32_bf16 v[68:71], v[44:47], v[12:15], v[68:71]
    v_mfma_f32_16x16x32_bf16 v[72:75], v[44:47], v[16:19], v[72:75]
    v_mfma_f32_16x16x32_bf16 v[76:79], v[44:47], v[20:23], v[76:79]
    v_mfma_f32_16x16x32_bf16 v[80:83], v[44:47], v[24:27], v[80:83]
    ds_read_b64_tr_b16 v[44:45], v7 offset:34816
    ds_read_b64_tr_b16 v[46:47], v8 offset:34816

    ds_read_b128 v[28:31], v6 offset:34816
    ds_read_b128 v[32:35], v6 offset:35840
    ds_read_b128 v[36:39], v6 offset:36864
    ds_read_b128 v[40:43], v6 offset:37888
    s_add_u32 m0, s84, 104448
    s_nop 0
    buffer_load_dwordx4 v3, s[64:67], s76 offen lds
    s_add_u32 s76, s76, s80

    s_waitcnt lgkmcnt(8)
    v_mfma_f32_16x16x32_bf16 v[84:87], v[48:51], v[12:15], v[84:87]
    v_mfma_f32_16x16x32_bf16 v[88:91], v[48:51], v[16:19], v[88:91]
    v_mfma_f32_16x16x32_bf16 v[92:95], v[48:51], v[20:23], v[92:95]
    v_mfma_f32_16x16x32_bf16 v[96:99], v[48:51], v[24:27], v[96:99]
    ds_read_b64_tr_b16 v[48:49], v7 offset:34848
    ds_read_b64_tr_b16 v[50:51], v8 offset:34848

    s_add_u32 m0, s85, 104448
    s_nop 0
    buffer_load_dwordx4 v4, s[68:71], s77 offen lds
    s_add_u32 s77, s77, s81

    s_waitcnt lgkmcnt(8)
    v_mfma_f32_16x16x32_bf16 v[100:103], v[52:55], v[12:15], v[100:103]
    v_mfma_f32_16x16x32_bf16 v[104:107], v[52:55], v[16:19], v[104:107]
    v_mfma_f32_16x16x32_bf16 v[108:111], v[52:55], v[20:23], v[108:111]
    v_mfma_f32_16x16x32_bf16 v[112:115], v[52:55], v[24:27], v[112:115]
    ds_read_b64_tr_b16 v[52:53], v7 offset:34880
    ds_read_b64_tr_b16 v[54:55], v8 offset:34880

    s_add_u32 m0, s86, 104448
    s_nop 0
    buffer_load_dwordx4 v5, s[72:75], s78 offen lds
    s_add_u32 s78, s78, s82

    s_waitcnt vmcnt(3)
    s_barrier
    s_waitcnt lgkmcnt(4)
    v_mfma_f32_16x16x32_bf16 v[68:71], v[44:47], v[28:31], v[68:71]
    v_mfma_f32_16x16x32_bf16 v[72:75], v[44:47], v[32:35], v[72:75]
    v_mfma_f32_16x16x32_bf16 v[76:79], v[44:47], v[36:39], v[76:79]
    v_mfma_f32_16x16x32_bf16 v[80:83], v[44:47], v[40:43], v[80:83]
    ds_read_b64_tr_b16 v[44:45], v10 offset:0
    ds_read_b64_tr_b16 v[46:47], v11 offset:0

    ds_read_b128 v[12:15], v9 offset:0
    ds_read_b128 v[16:19], v9 offset:1024
    ds_read_b128 v[20:23], v9 offset:2048
    ds_read_b128 v[24:27], v9 offset:3072
    s_add_u32 m0, s84, 0
    s_nop 0
    buffer_load_dwordx4 v3, s[64:67], s76 offen lds
    s_add_u32 s76, s76, s80

    s_waitcnt lgkmcnt(8)
    v_mfma_f32_16x16x32_bf16 v[84:87], v[48:51], v[28:31], v[84:87]
    v_mfma_f32_16x16x32_bf16 v[88:91], v[48:51], v[32:35], v[88:91]
    v_mfma_f32_16x16x32_bf16 v[92:95], v[48:51], v[36:39], v[92:95]
    v_mfma_f32_16x16x32_bf16 v[96:99], v[48:51], v[40:43], v[96:99]
    ds_read_b64_tr_b16 v[48:49], v10 offset:32
    ds_read_b64_tr_b16 v[50:51], v11 offset:32

    s_add_u32 m0, s85, 0
    s_nop 0
    buffer_load_dwordx4 v4, s[68:71], s77 offen lds
    s_add_u32 s77, s77, s81

    s_waitcnt lgkmcnt(8)
    v_mfma_f32_16x16x32_bf16 v[100:103], v[52:55], v[28:31], v[100:103]
    v_mfma_f32_16x16x32_bf16 v[104:107], v[52:55], v[32:35], v[104:107]
    v_mfma_f32_16x16x32_bf16 v[108:111], v[52:55], v[36:39], v[108:111]
    v_mfma_f32_16x16x32_bf16 v[112:115], v[52:55], v[40:43], v[112:115]
    ds_read_b64_tr_b16 v[52:53], v10 offset:64
    ds_read_b64_tr_b16 v[54:55], v11 offset:64

    s_add_u32 m0, s86, 0
    s_nop 0
    buffer_load_dwordx4 v5, s[72:75], s78 offen lds
    s_add_u32 s78, s78, s82

    s_waitcnt vmcnt(3)
    s_barrier
    s_waitcnt lgkmcnt(4)
    v_mfma_f32_16x16x32_bf16 v[68:71], v[44:47], v[12:15], v[68:71]
    v_mfma_f32_16x16x32_bf16 v[72:75], v[44:47], v[16:19], v[72:75]
    v_mfma_f32_16x16x32_bf16 v[76:79], v[44:47], v[20:23], v[76:79]
    v_mfma_f32_16x16x32_bf16 v[80:83], v[44:47], v[24:27], v[80:83]
    ds_read_b64_tr_b16 v[44:45], v10 offset:34816
    ds_read_b64_tr_b16 v[46:47], v11 offset:34816

    ds_read_b128 v[28:31], v9 offset:34816
    ds_read_b128 v[32:35], v9 offset:35840
    ds_read_b128 v[36:39], v9 offset:36864
    ds_read_b128 v[40:43], v9 offset:37888
    s_add_u32 m0, s84, 34816
    s_nop 0
    buffer_load_dwordx4 v3, s[64:67], s76 offen lds
    s_add_u32 s76, s76, s80

    s_waitcnt lgkmcnt(8)
    v_mfma_f32_16x16x32_bf16 v[84:87], v[48:51], v[12:15], v[84:87]
    v_mfma_f32_16x16x32_bf16 v[88:91], v[48:51], v[16:19], v[88:91]
    v_mfma_f32_16x16x32_bf16 v[92:95], v[48:51], v[20:23], v[92:95]
    v_mfma_f32_16x16x32_bf16 v[96:99], v[48:51], v[24:27], v[96:99]
    ds_read_b64_tr_b16 v[48:49], v10 offset:34848
    ds_read_b64_tr_b16 v[50:51], v11 offset:34848

    s_add_u32 m0, s85, 34816
    s_nop 0
    buffer_load_dwordx4 v4, s[68:71], s77 offen lds
    s_add_u32 s77, s77, s81

    s_waitcnt lgkmcnt(8)
    v_mfma_f32_16x16x32_bf16 v[100:103], v[52:55], v[12:15], v[100:103]
    v_mfma_f32_16x16x32_bf16 v[104:107], v[52:55], v[16:19], v[104:107]
    v_mfma_f32_16x16x32_bf16 v[108:111], v[52:55], v[20:23], v[108:111]
    v_mfma_f32_16x16x32_bf16 v[112:115], v[52:55], v[24:27], v[112:115]
    ds_read_b64_tr_b16 v[52:53], v10 offset:34880
    ds_read_b64_tr_b16 v[54:55], v11 offset:34880

    s_add_u32 m0, s86, 34816
    s_nop 0
    buffer_load_dwordx4 v5, s[72:75], s78 offen lds
    s_add_u32 s78, s78, s82

    s_waitcnt vmcnt(3)
    s_barrier
    s_waitcnt lgkmcnt(4)
    v_mfma_f32_16x16x32_bf16 v[68:71], v[44:47], v[28:31], v[68:71]
    v_mfma_f32_16x16x32_bf16 v[72:75], v[44:47], v[32:35], v[72:75]
    v_mfma_f32_16x16x32_bf16 v[76:79], v[44:47], v[36:39], v[76:79]
    v_mfma_f32_16x16x32_bf16 v[80:83], v[44:47], v[40:43], v[80:83]
    ds_read_b64_tr_b16 v[44:45], v7 offset:0
    ds_read_b64_tr_b16 v[46:47], v8 offset:0

    ds_read_b128 v[12:15], v6 offset:0
    ds_read_b128 v[16:19], v6 offset:1024
    ds_read_b128 v[20:23], v6 offset:2048
    ds_read_b128 v[24:27], v6 offset:3072
    s_waitcnt lgkmcnt(8)
    v_mfma_f32_16x16x32_bf16 v[84:87], v[48:51], v[28:31], v[84:87]
    v_mfma_f32_16x16x32_bf16 v[88:91], v[48:51], v[32:35], v[88:91]
    v_mfma_f32_16x16x32_bf16 v[92:95], v[48:51], v[36:39], v[92:95]
    v_mfma_f32_16x16x32_bf16 v[96:99], v[48:51], v[40:43], v[96:99]
    ds_read_b64_tr_b16 v[48:49], v7 offset:32
    ds_read_b64_tr_b16 v[50:51], v8 offset:32

    s_waitcnt lgkmcnt(8)
    v_mfma_f32_16x16x32_bf16 v[100:103], v[52:55], v[28:31], v[100:103]
    v_mfma_f32_16x16x32_bf16 v[104:107], v[52:55], v[32:35], v[104:107]
    v_mfma_f32_16x16x32_bf16 v[108:111], v[52:55], v[36:39], v[108:111]
    v_mfma_f32_16x16x32_bf16 v[112:115], v[52:55], v[40:43], v[112:115]
    ds_read_b64_tr_b16 v[52:53], v7 offset:64
    ds_read_b64_tr_b16 v[54:55], v8 offset:64

    s_waitcnt vmcnt(0)
    s_barrier
    s_waitcnt lgkmcnt(4)
    v_mfma_f32_16x16x32_bf16 v[68:71], v[44:47], v[12:15], v[68:71]
    v_mfma_f32_16x16x32_bf16 v[72:75], v[44:47], v[16:19], v[72:75]
    v_mfma_f32_16x16x32_bf16 v[76:79], v[44:47], v[20:23], v[76:79]
    v_mfma_f32_16x16x32_bf16 v[80:83], v[44:47], v[24:27], v[80:83]
    ds_read_b64_tr_b16 v[44:45], v7 offset:34816
    ds_read_b64_tr_b16 v[46:47], v8 offset:34816

    ds_read_b128 v[28:31], v6 offset:34816
    ds_read_b128 v[32:35], v6 offset:35840
    ds_read_b128 v[36:39], v6 offset:36864
    ds_read_b128 v[40:43], v6 offset:37888
    s_waitcnt lgkmcnt(8)
    v_mfma_f32_16x16x32_bf16 v[84:87], v[48:51], v[12:15], v[84:87]
    v_mfma_f32_16x16x32_bf16 v[88:91], v[48:51], v[16:19], v[88:91]
    v_mfma_f32_16x16x32_bf16 v[92:95], v[48:51], v[20:23], v[92:95]
    v_mfma_f32_16x16x32_bf16 v[96:99], v[48:51], v[24:27], v[96:99]
    ds_read_b64_tr_b16 v[48:49], v7 offset:34848
    ds_read_b64_tr_b16 v[50:51], v8 offset:34848

    s_waitcnt lgkmcnt(8)
    v_mfma_f32_16x16x32_bf16 v[100:103], v[52:55], v[12:15], v[100:103]
    v_mfma_f32_16x16x32_bf16 v[104:107], v[52:55], v[16:19], v[104:107]
    v_mfma_f32_16x16x32_bf16 v[108:111], v[52:55], v[20:23], v[108:111]
    v_mfma_f32_16x16x32_bf16 v[112:115], v[52:55], v[24:27], v[112:115]
    ds_read_b64_tr_b16 v[52:53], v7 offset:34880
    ds_read_b64_tr_b16 v[54:55], v8 offset:34880

    s_waitcnt lgkmcnt(0)
    v_mfma_f32_16x16x32_bf16 v[68:71], v[44:47], v[28:31], v[68:71]
    v_mfma_f32_16x16x32_bf16 v[72:75], v[44:47], v[32:35], v[72:75]
    v_mfma_f32_16x16x32_bf16 v[76:79], v[44:47], v[36:39], v[76:79]
    v_mfma_f32_16x16x32_bf16 v[80:83], v[44:47], v[40:43], v[80:83]
    v_mfma_f32_16x16x32_bf16 v[84:87], v[48:51], v[28:31], v[84:87]
    v_mfma_f32_16x16x32_bf16 v[88:91], v[48:51], v[32:35], v[88:91]
    v_mfma_f32_16x16x32_bf16 v[92:95], v[48:51], v[36:39], v[92:95]
    v_mfma_f32_16x16x32_bf16 v[96:99], v[48:51], v[40:43], v[96:99]
    v_mfma_f32_16x16x32_bf16 v[100:103], v[52:55], v[28:31], v[100:103]
    v_mfma_f32_16x16x32_bf16 v[104:107], v[52:55], v[32:35], v[104:107]
    v_mfma_f32_16x16x32_bf16 v[108:111], v[52:55], v[36:39], v[108:111]
    v_mfma_f32_16x16x32_bf16 v[112:115], v[52:55], v[40:43], v[112:115]
    s_nop 7
    s_nop 7
    s_barrier
    v_lshlrev_b32 v5, 4, v2
    s_mul_i32 s3, s93, 12288
    v_add_u32 v5, s3, v5
    s_cmp_eq_u32 s39, 0
    s_cbranch_scc1 g2r_1

    ds_write_b128 v5, v[68:71] offset:0
    ds_write_b128 v5, v[72:75] offset:1024
    ds_write_b128 v5, v[76:79] offset:2048
    ds_write_b128 v5, v[80:83] offset:3072
    ds_write_b128 v5, v[84:87] offset:4096
    ds_write_b128 v5, v[88:91] offset:5120
    ds_write_b128 v5, v[92:95] offset:6144
    ds_write_b128 v5, v[96:99] offset:7168
    ds_write_b128 v5, v[100:103] offset:8192
    ds_write_b128 v5, v[104:107] offset:9216
    ds_write_b128 v5, v[108:111] offset:10240
    ds_write_b128 v5, v[112:115] offset:11264
    s_waitcnt lgkmcnt(0)
    s_barrier
    s_branch gemm2_done
g2r_1:
    s_barrier
    ds_read_b128 v[12:15], v5 offset:0
    ds_read_b128 v[16:19], v5 offset:1024
    ds_read_b128 v[20:23], v5 offset:2048
    ds_read_b128 v[24:27], v5 offset:3072
    ds_read_b128 v[28:31], v5 offset:4096
    ds_read_b128 v[32:35], v5 offset:5120
    ds_read_b128 v[36:39], v5 offset:6144
    ds_read_b128 v[40:43], v5 offset:7168
    ds_read_b128 v[44:47], v5 offset:8192
    ds_read_b128 v[48:51], v5 offset:9216
    ds_read_b128 v[52:55], v5 offset:10240
    ds_read_b128 v[56:59], v5 offset:11264
    s_waitcnt lgkmcnt(0)
    v_add_f32 v68, v68, v12
    v_add_f32 v69, v69, v13
    v_add_f32 v70, v70, v14
    v_add_f32 v71, v71, v15
    v_add_f32 v72, v72, v16
    v_add_f32 v73, v73, v17
    v_add_f32 v74, v74, v18
    v_add_f32 v75, v75, v19
    v_add_f32 v76, v76, v20
    v_add_f32 v77, v77, v21
    v_add_f32 v78, v78, v22
    v_add_f32 v79, v79, v23
    v_add_f32 v80, v80, v24
    v_add_f32 v81, v81, v25
    v_add_f32 v82, v82, v26
    v_add_f32 v83, v83, v27
    v_add_f32 v84, v84, v28
    v_add_f32 v85, v85, v29
    v_add_f32 v86, v86, v30
    v_add_f32 v87, v87, v31
    v_add_f32 v88, v88, v32
    v_add_f32 v89, v89, v33
    v_add_f32 v90, v90, v34
    v_add_f32 v91, v91, v35
    v_add_f32 v92, v92, v36
    v_add_f32 v93, v93, v37
    v_add_f32 v94, v94, v38
    v_add_f32 v95, v95, v39
    v_add_f32 v96, v96, v40
    v_add_f32 v97, v97, v41
    v_add_f32 v98, v98, v42
    v_add_f32 v99, v99, v43
    v_add_f32 v100, v100, v44
    v_add_f32 v101, v101, v45
    v_add_f32 v102, v102, v46
    v_add_f32 v103, v103, v47
    v_add_f32 v104, v104, v48
    v_add_f32 v105, v105, v49
    v_add_f32 v106, v106, v50
    v_add_f32 v107, v107, v51
    v_add_f32 v108, v108, v52
    v_add_f32 v109, v109, v53
    v_add_f32 v110, v110, v54
    v_add_f32 v111, v111, v55
    v_add_f32 v112, v112, v56
    v_add_f32 v113, v113, v57
    v_add_f32 v114, v114, v58
    v_add_f32 v115, v115, v59
    v_and_b32 v3, 15, v2
    v_lshrrev_b32 v4, 4, v2
    s_lshl_b32 s3, s22, 7
    v_add_u32 v3, s3, v3
    s_lshl_b32 s3, s27, 6
    v_add_u32 v3, s3, v3
    v_mul_u32_u24 v3, 2304, v3
    v_lshlrev_b32 v4, 4, v4
    v_add_u32 v3, v3, v4
    s_mul_i32 s3, s23, 576
    v_add_u32 v3, s3, v3
    s_mul_i32 s3, s28, 192
    v_add_u32 v3, s3, v3
    s_mul_i32 s3, s25, 4718592

    v_add_u32 v4, 0, v3
    buffer_store_dwordx4 v[68:71], v4, s[32:35], s3 offen offset:0

    v_add_u32 v4, 36864, v3
    buffer_store_dwordx4 v[72:75], v4, s[32:35], s3 offen offset:0

    v_add_u32 v4, 73728, v3
    buffer_store_dwordx4 v[76:79], v4, s[32:35], s3 offen offset:0

    v_add_u32 v4, 110592, v3
    buffer_store_dwordx4 v[80:83], v4, s[32:35], s3 offen offset:0

    v_add_u32 v4, 0, v3
    buffer_store_dwordx4 v[84:87], v4, s[32:35], s3 offen offset:64

    v_add_u32 v4, 36864, v3
    buffer_store_dwordx4 v[88:91], v4, s[32:35], s3 offen offset:64

    v_add_u32 v4, 73728, v3
    buffer_store_dwordx4 v[92:95], v4, s[32:35], s3 offen offset:64

    v_add_u32 v4, 110592, v3
    buffer_store_dwordx4 v[96:99], v4, s[32:35], s3 offen offset:64

    v_add_u32 v4, 0, v3
    buffer_store_dwordx4 v[100:103], v4, s[32:35], s3 offen offset:128

    v_add_u32 v4, 36864, v3
    buffer_store_dwordx4 v[104:107], v4, s[32:35], s3 offen offset:128

    v_add_u32 v4, 73728, v3
    buffer_store_dwordx4 v[108:111], v4, s[32:35], s3 offen offset:128

    v_add_u32 v4, 110592, v3
    buffer_store_dwordx4 v[112:115], v4, s[32:35], s3 offen offset:128

gemm2_done:
    s_endpgm
.section .rodata,"a"
.p2align 6
.amdhsa_kernel pre_kernel
  .amdhsa_next_free_vgpr 64
  .amdhsa_next_free_sgpr 102
  .amdhsa_accum_offset 64
  .amdhsa_group_segment_fixed_size 0
  .amdhsa_kernarg_size 104
  .amdhsa_user_sgpr_count 2
  .amdhsa_user_sgpr_kernarg_segment_ptr 1
  .amdhsa_system_sgpr_workgroup_id_x 1
.end_amdhsa_kernel
.p2align 6
.amdhsa_kernel conv_kernel
  .amdhsa_next_free_vgpr 144
  .amdhsa_next_free_sgpr 102
  .amdhsa_accum_offset 144
  .amdhsa_group_segment_fixed_size 0
  .amdhsa_kernarg_size 104
  .amdhsa_user_sgpr_count 2
  .amdhsa_user_sgpr_kernarg_segment_ptr 1
  .amdhsa_system_sgpr_workgroup_id_x 1
.end_amdhsa_kernel
.p2align 6
.amdhsa_kernel row0_kernel
  .amdhsa_next_free_vgpr 144
  .amdhsa_next_free_sgpr 102
  .amdhsa_accum_offset 144
  .amdhsa_group_segment_fixed_size 0
  .amdhsa_kernarg_size 104
  .amdhsa_user_sgpr_count 2
  .amdhsa_user_sgpr_kernarg_segment_ptr 1
  .amdhsa_system_sgpr_workgroup_id_x 1
.end_amdhsa_kernel
.p2align 6
.amdhsa_kernel row1_kernel
  .amdhsa_next_free_vgpr 144
  .amdhsa_next_free_sgpr 102
  .amdhsa_accum_offset 144
  .amdhsa_group_segment_fixed_size 0
  .amdhsa_kernarg_size 104
  .amdhsa_user_sgpr_count 2
  .amdhsa_user_sgpr_kernarg_segment_ptr 1
  .amdhsa_system_sgpr_workgroup_id_x 1
.end_amdhsa_kernel
.p2align 6
.amdhsa_kernel row2_kernel
  .amdhsa_next_free_vgpr 144
  .amdhsa_next_free_sgpr 102
  .amdhsa_accum_offset 144
  .amdhsa_group_segment_fixed_size 0
  .amdhsa_kernarg_size 104
  .amdhsa_user_sgpr_count 2
  .amdhsa_user_sgpr_kernarg_segment_ptr 1
  .amdhsa_system_sgpr_workgroup_id_x 1
.end_amdhsa_kernel
.p2align 6
.amdhsa_kernel gemm1_kernel
  .amdhsa_next_free_vgpr 164
  .amdhsa_next_free_sgpr 102
  .amdhsa_accum_offset 164
  .amdhsa_group_segment_fixed_size 0
  .amdhsa_kernarg_size 104
  .amdhsa_user_sgpr_count 2
  .amdhsa_user_sgpr_kernarg_segment_ptr 1
  .amdhsa_system_sgpr_workgroup_id_x 1
.end_amdhsa_kernel
.p2align 6
.amdhsa_kernel gemm2_kernel
  .amdhsa_next_free_vgpr 116
  .amdhsa_next_free_sgpr 102
  .amdhsa_accum_offset 116
  .amdhsa_group_segment_fixed_size 0
  .amdhsa_kernarg_size 104
  .amdhsa_user_sgpr_count 2
  .amdhsa_user_sgpr_kernarg_segment_ptr 1
  .amdhsa_system_sgpr_workgroup_id_x 1
.end_amdhsa_kernel
```
